```python
import torch

def _softmax(x, axis=-1):
    return torch.softmax(x, dim=axis)
def _gelu(x):
    return torch.nn.functional.gelu(x, approximate="tanh")
def _silu(x):
    return torch.nn.functional.silu(x)
def _sigmoid(x):
    return torch.sigmoid(x)
def _layernorm(x, axis=-1, eps=1e-5):
    m = x.mean(dim=axis, keepdim=True)
    v = x.var(dim=axis, keepdim=True, unbiased=False)
    return (x - m) / torch.sqrt(v + eps)
def _scatter_add(tgt, idx, src, axis=0):
    return tgt.clone().index_add_(axis, idx, src)
def _segment_sum(src, seg, n):
    out = torch.zeros((n,) + src.shape[1:], dtype=src.dtype)
    return out.index_add_(0, seg, src)
def _pad(x, pw):
    flat = tuple(v for pair in reversed(pw) for v in pair)
    return torch.nn.functional.pad(x, flat)

kernel_name = 'standalone__edm_precond__diffusion'

def setup_inputs():

    _w = (lambda a: (lambda t: t.to(torch.bfloat16) if t.is_floating_point() else t)(torch.as_tensor(a)))
    B, C, HW = 2, 320, 128
    return {
        "x": _w((lambda *s: torch.randn(*s, dtype=torch.bfloat16) * 0.2)(B, C, HW, HW)),
        "sigma": _w((lambda _x: torch.exp(torch.as_tensor(_x)))((lambda *s: torch.randn(*s, dtype=torch.bfloat16) * 3.2)(B))),
        "w_in": _w((lambda *s: torch.randn(*s, dtype=torch.bfloat16) * 3.2)(C, C) * (C ** -0.5)),
        "w_emb": _w((lambda *s: torch.randn(*s, dtype=torch.bfloat16) * 3.2)(1, C)),
        "w_out": _w((lambda *s: torch.randn(*s, dtype=torch.bfloat16) * 3.2)(C, C) * (C ** -0.5)),
    }

def reference(x, sigma, w_in, w_emb, w_out):
    B, C, H, W = x.shape
    sigma_data = 0.5
    s = sigma.reshape(B, 1, 1, 1)
    denom = s * s + sigma_data * sigma_data
    c_skip = (sigma_data * sigma_data) / denom
    c_out  = s * sigma_data / torch.sqrt(denom)
    c_in   = 1.0 / torch.sqrt(denom)
    c_noise = 0.25 * torch.log(sigma).reshape(B, 1)
    h = torch.einsum("bchw,cd->bdhw", c_in * x, w_in)
    h = h + (c_noise @ w_emb).reshape(B, C, 1, 1)
    h = _silu(h)
    Fx = torch.einsum("bchw,cd->bdhw", h, w_out)
    return c_skip * x + c_out * Fx
```

```asm
; @launch grid=(256,1,1) block=(256,1,1) lds=163840
.amdgcn_target "amdgcn-amd-amdhsa--gfx950"
.text
.globl standalone__edm_precond__diffusion_kernel
.p2align 12
.p2align 8
.type standalone__edm_precond__diffusion_kernel,@function
standalone__edm_precond__diffusion_kernel:
  s_cmp_ge_u32 s2, 256
  s_cbranch_scc1 L_end
  s_load_dwordx4 s[4:7], s[0:1], 0
  s_load_dwordx4 s[8:11], s[0:1], 16
  s_load_dwordx4 s[12:15], s[0:1], 32
  s_getpc_b64 s[56:57]
L_pc:
  s_bfe_u32 s45, s2, 0x10004
  s_lshl_b32 s45, s45, 14
  v_lshlrev_b32 v238, 6, v0
  v_add_u32 v238, s45, v238
  v_min_u32 v238, L_end-L_pc, v238
  global_load_dword a240, v238, s[56:57]
  v_lshrrev_b32 v225, 6, v0
  v_and_b32 v224, 63, v0
  v_readfirstlane_b32 s36, v225
  v_lshrrev_b32 v226, 3, v0
  v_bfe_u32 v227, v0, 4, 2
  v_lshl_or_b32 v227, v227, 2, v227
  v_and_b32 v227, 6, v227
  v_xor_b32 v227, v227, v0
  v_and_b32 v227, 7, v227
  v_lshlrev_b32 v227, 4, v227
  v_lshl_add_u32 v249, v226, 15, v227
  v_mul_u32_u24 v226, 640, v226
  v_add_u32 v248, v226, v227
  v_lshrrev_b32 v228, 3, v224
  v_min_u32 v228, 4, v228
  v_and_b32 v229, 7, v224
  v_lshlrev_b32 v229, 2, v229
  v_lshl_add_u32 v229, v228, 7, v229
  v_lshl_add_u32 v237, v225, 5, v229
  s_lshr_b32 s39, s2, 7
  s_and_b32 s41, s2, 127
  s_mul_i32 s40, s39, 10485760
  s_lshl_b32 s41, s41, 8
  s_add_u32 s40, s40, s41
  s_sub_u32 s18, 20971520, s40
  s_lshl_b32 s37, s36, 10
  s_mov_b32 s19, 0x20000
  s_mov_b32 s23, 0x20000
  s_mov_b32 s22, 204800
  s_lshr_b32 s44, s2, 3
  s_mul_i32 s45, s44, 26
  s_lshr_b32 s45, s45, 8
  s_mul_i32 s45, s45, 10
  s_sub_u32 s88, s44, s45
  s_lshl_b32 s74, s88, 20
  s_mul_hi_u32 s64, s74, 83886080
  s_add_u32 s75, s74, 1048576
  s_cmp_eq_u32 s88, 9
  s_cselect_b32 s75, 0, s75
  s_mul_hi_u32 s65, s75, 83886080
  s_add_u32 s76, s75, 1048576
  s_cmp_eq_u32 s88, 8
  s_cselect_b32 s76, 0, s76
  s_mul_hi_u32 s66, s76, 83886080
  s_add_u32 s77, s76, 1048576
  s_cmp_eq_u32 s88, 7
  s_cselect_b32 s77, 0, s77
  s_mul_hi_u32 s67, s77, 83886080
  s_add_u32 s78, s77, 1048576
  s_cmp_eq_u32 s88, 6
  s_cselect_b32 s78, 0, s78
  s_mul_hi_u32 s68, s78, 83886080
  s_add_u32 s79, s78, 1048576
  s_cmp_eq_u32 s88, 5
  s_cselect_b32 s79, 0, s79
  s_mul_hi_u32 s69, s79, 83886080
  s_add_u32 s80, s79, 1048576
  s_cmp_eq_u32 s88, 4
  s_cselect_b32 s80, 0, s80
  s_mul_hi_u32 s70, s80, 83886080
  s_add_u32 s81, s80, 1048576
  s_cmp_eq_u32 s88, 3
  s_cselect_b32 s81, 0, s81
  s_mul_hi_u32 s71, s81, 83886080
  s_add_u32 s82, s81, 1048576
  s_cmp_eq_u32 s88, 2
  s_cselect_b32 s82, 0, s82
  s_mul_hi_u32 s72, s82, 83886080
  s_add_u32 s83, s82, 1048576
  s_cmp_eq_u32 s88, 1
  s_cselect_b32 s83, 0, s83
  s_mul_hi_u32 s73, s83, 83886080
  s_lshl2_add_u32 s44, s44, s36
  s_add_u32 m0, s37, 81920
  s_waitcnt lgkmcnt(0)
  s_add_u32 s16, s4, s40
  s_addc_u32 s17, s5, 0
  global_load_dword v239, v237, s[10:11]
  buffer_load_dwordx4 v249, s[16:19], s74 offen nt lds
  s_load_dword s42, s[6:7], 0
  s_mov_b32 s20, s8
  s_mov_b32 s21, s9
  v_min_u32 v238, 12, v224
  v_lshlrev_b32 v238, 7, v238
  s_add_u32 m0, s37, 139264
  s_mov_b32 s47, 0xffff0000
  buffer_load_dwordx4 v248, s[20:23], s64 offen lds
  s_add_u32 m0, s37, 86016
  v_bfe_u32 v230, v224, 4, 1
  buffer_load_dwordx4 v249, s[16:19], s75 offen nt lds
  s_add_u32 m0, s37, 143360
  v_and_b32 v233, 3, v224
  buffer_load_dwordx4 v248, s[20:23], s65 offen lds
  v_lshlrev_b32 v233, 3, v233
  v_lshrrev_b32 v232, 2, v224
  v_lshl_add_u32 v233, v232, 7, v233
  v_bfe_u32 v232, v224, 3, 1
  v_lshl_add_u32 v233, v232, 6, v233
  v_lshl_add_u32 v233, v230, 5, v233
  v_add_u32 v240, 81920, v233
  v_xor_b32 v241, 32, v240
  v_xor_b32 v242, 64, v240
  v_xor_b32 v243, 96, v240
  v_lshlrev_b32 v232, 5, v225
  v_xor_b32 v251, v232, v233
  v_add_u32 v250, 16384, v251
  v_add_u32 v253, 122880, v251
  v_lshlrev_b32 v232, 10, v225
  v_lshl_add_u32 v231, v224, 3, v232
  v_and_b32 v233, 0x30, v224
  s_mul_i32 s58, s44, 1664
  s_min_u32 s58, s58, 203136
  buffer_load_dword a240, v238, s[20:23], s58 offen
  v_add_u32 v252, v232, v233
  s_waitcnt lgkmcnt(0)
  s_lshl_b32 s45, s42, 16
  s_and_b32 s46, s42, 0xffff0000
  s_cmp_eq_u32 s39, 0
  s_cselect_b32 s43, s45, s46
  v_mul_f32_e64 v226, s43, s43
  v_log_f32 v229, s43
  v_cvt_pk_bf16_f32 v226, v226, v226
  v_and_b32 v226, s47, v226
  v_add_f32 v226, 0x3e800000, v226
  v_mul_f32 v229, 0x3f317218, v229
  v_cvt_pk_bf16_f32 v226, v226, v226
  v_and_b32 v226, s47, v226
  v_sqrt_f32 v227, v226
  v_cvt_pk_bf16_f32 v229, v229, v229
  v_and_b32 v229, s47, v229
  s_add_u32 m0, s37, 90112
  v_mul_f32 v229, 0x3e800000, v229
  v_cvt_pk_bf16_f32 v227, v227, v227
  buffer_load_dwordx4 v249, s[16:19], s76 offen nt lds
  v_and_b32 v227, s47, v227
  v_rcp_f32 v228, v227
  v_cvt_pk_bf16_f32 v229, v229, v229
  v_and_b32 v229, s47, v229
  v_cvt_pk_bf16_f32 v237, v228, v228
  v_and_b32 v237, s47, v237
  v_rcp_f32 v233, v237
  s_add_u32 m0, s37, 147456
  s_nop 0
  buffer_load_dwordx4 v248, s[20:23], s66 offen lds
  s_add_u32 m0, s37, 94208
  s_nop 0
  buffer_load_dwordx4 v249, s[16:19], s77 offen nt lds
  s_add_u32 m0, s37, 151552
  s_nop 0
  buffer_load_dwordx4 v248, s[20:23], s67 offen lds
  s_add_u32 m0, s37, 98304
  s_nop 0
  buffer_load_dwordx4 v249, s[16:19], s78 offen nt lds
  s_waitcnt vmcnt(10)
  v_lshlrev_b32 v234, 16, v239
  v_and_b32 v235, s47, v239
  v_mul_f32 v234, v234, v229
  v_mul_f32 v235, v235, v229
  v_cvt_pk_bf16_f32 v239, v234, v235
  v_lshlrev_b32 v234, 16, v239
  v_and_b32 v235, s47, v239
  v_mul_f32 v234, v234, v233
  v_mul_f32 v235, v235, v233
  ds_write_b64 v231, v[234:235]
  s_add_u32 m0, s37, 155648
  s_nop 0
  buffer_load_dwordx4 v248, s[20:23], s68 offen lds
  s_add_u32 m0, s37, 102400
  s_nop 0
  buffer_load_dwordx4 v249, s[16:19], s79 offen nt lds
  ds_read_b128 v[0:3], v252
  s_waitcnt vmcnt(10)
  s_barrier
  ds_read_b64_tr_b16 a[0:1], v253 offset:16384
  ds_read_b64_tr_b16 a[2:3], v253 offset:18432
  ds_read_b64_tr_b16 v[4:5], v240
  ds_read_b64_tr_b16 v[6:7], v240 offset:2048
  ds_read_b64_tr_b16 v[8:9], v241
  ds_read_b64_tr_b16 v[10:11], v241 offset:2048
  ds_read_b64_tr_b16 v[12:13], v242
  ds_read_b64_tr_b16 v[14:15], v242 offset:2048
  ds_read_b64_tr_b16 v[16:17], v243
  ds_read_b64_tr_b16 v[18:19], v243 offset:2048
  s_waitcnt lgkmcnt(6)
  v_mfma_f32_16x16x32_bf16 v[20:23], a[0:3], v[4:7], v[0:3]
  s_waitcnt lgkmcnt(4)
  s_add_u32 m0, s37, 159744
  v_mfma_f32_16x16x32_bf16 v[24:27], a[0:3], v[8:11], v[0:3]
  s_waitcnt lgkmcnt(2)
  v_mfma_f32_16x16x32_bf16 v[28:31], a[0:3], v[12:15], v[0:3]
  s_waitcnt lgkmcnt(0)
  v_mfma_f32_16x16x32_bf16 v[0:3], a[0:3], v[16:19], v[0:3]
  buffer_load_dwordx4 v248, s[20:23], s69 offen lds
  s_add_u32 m0, s37, 106496
  s_nop 0
  buffer_load_dwordx4 v249, s[16:19], s80 offen nt lds
  s_mov_b32 s27, 0x20000
  s_mov_b32 s26, 204800
  s_mov_b32 s24, s12
  s_mov_b32 s25, s13
  s_mov_b32 s31, 0x20000
  s_mov_b32 s30, s18
  s_add_u32 s28, s14, s40
  s_addc_u32 s29, s15, 0
  s_lshr_b32 s45, s36, 1
  s_cmp_lt_u32 s45, s88
  s_cselect_b32 s46, 10, 0
  s_sub_u32 s46, s46, s88
  s_add_u32 s45, s45, s46
  s_lshl_b32 s46, s46, 12
  s_add_u32 s46, s46, 81920
  s_cmp_ge_u32 s45, 8
  s_cselect_b32 s32, -8, 2
  s_add_i32 s45, s45, s32
  s_lshl_b32 s32, s32, 12
  s_cmp_ge_u32 s45, 8
  s_cselect_b32 s33, -8, 2
  s_add_i32 s45, s45, s33
  s_lshl_b32 s33, s33, 12
  s_cmp_ge_u32 s45, 8
  s_cselect_b32 s34, -8, 2
  s_add_i32 s45, s45, s34
  s_lshl_b32 s34, s34, 12
  s_cmp_ge_u32 s45, 8
  s_cselect_b32 s35, -8, 2
  s_add_i32 s45, s45, s35
  s_lshl_b32 s35, s35, 12
  s_cmp_ge_u32 s45, 8
  s_cselect_b32 s87, -8, 2
  s_add_i32 s45, s45, s87
  s_lshl_b32 s87, s87, 12
  s_add_u32 s87, s87, 40960
  s_lshr_b32 s45, s36, 1
  s_mul_i32 s38, s45, 30720
  s_sub_u32 s45, s45, s36
  s_lshl_b32 s45, s45, 9
  s_and_b32 s53, s36, 1
  s_add_u32 s53, s53, s45
  s_lshl_b32 s53, s53, 3
  s_sub_u32 s54, -40960, s53
  v_lshlrev_b32 v229, 5, v230
  v_lshrrev_b32 v230, 4, v224
  v_lshl_add_u32 v233, v225, 2, v230
  v_and_b32 v232, 15, v224
  v_lshlrev_b32 v232, 3, v232
  v_lshl_add_u32 v234, v233, 17, v232
  v_accvgpr_write_b32 a244, v234
  v_lshl_add_u32 v233, v233, 9, v232
  v_xor_b32 v233, v233, v229
  v_add_u32 v254, s46, v233
  v_xor_b32 v255, 64, v254
  v_add_u32 v255, 256, v255
  v_lshlrev_b32 v232, 4, v224
  v_lshl_add_u32 v232, v225, 12, v232
  v_add_u32 v220, 81920, v232
  v_xor_b32 v221, 16, v220
  v_xor_b32 v222, 32, v220
  v_xor_b32 v223, 48, v220
  v_bfe_u32 v229, v224, 2, 2
  v_and_b32 v231, 3, v224
  v_lshlrev_b32 v232, 8, v230
  v_lshl_add_u32 v232, v231, 6, v232
  v_lshl_add_u32 v232, v229, 4, v232
  v_lshl_add_u32 v232, v229, 10, v232
  v_add_u32 v244, 81920, v232
  v_xor_b32 v245, 16, v244
  v_xor_b32 v246, 32, v244
  v_mov_b32 v247, v238
  v_rcp_f32 v236, v226
  v_mul_f32_e64 v230, 0.5, s43
  v_cvt_pk_bf16_f32 v230, v230, v230
  v_and_b32 v230, s47, v230
  v_mul_f32 v236, 0x3e800000, v236
  v_mul_f32 v230, v230, v228
  v_cvt_pk_bf16_f32 v230, v230, v230
  v_and_b32 v230, s47, v230
  v_cvt_pk_bf16_f32 v236, v236, v236
  v_and_b32 v236, s47, v236
  v_mul_f32 v230, 0xbf317218, v230
  v_rcp_f32 v230, v230
  v_mul_f32 v237, 0xbfb8aa3b, v237
  v_max_f32 v230, 0xfe967699, v230
  v_readfirstlane_b32 s52, v236
  v_readfirstlane_b32 s48, v237
  v_readfirstlane_b32 s49, v237
  v_readfirstlane_b32 s50, v230
  v_readfirstlane_b32 s51, v230
  s_mov_b32 vcc_lo, 0x100001
  s_mov_b32 vcc_hi, 0x10000100
  v_cndmask_b32 v232, 0, v236, vcc
  v_lshrrev_b32 v233, 16, v232
  v_accvgpr_write_b32 a252, v232
  v_accvgpr_write_b32 a248, v233
  s_mov_b32 vcc_lo, 0x200002
  s_mov_b32 vcc_hi, 0x20000200
  v_cndmask_b32 v232, 0, v236, vcc
  v_lshrrev_b32 v233, 16, v232
  v_accvgpr_write_b32 a253, v232
  v_accvgpr_write_b32 a249, v233
  s_mov_b32 vcc_lo, 0x400004
  s_mov_b32 vcc_hi, 0x40000400
  v_cndmask_b32 v232, 0, v236, vcc
  v_lshrrev_b32 v233, 16, v232
  v_accvgpr_write_b32 a254, v232
  v_accvgpr_write_b32 a250, v233
  s_mov_b32 vcc_lo, 0x800008
  s_mov_b32 vcc_hi, 0x80000800
  v_cndmask_b32 v232, 0, v236, vcc
  v_lshrrev_b32 v233, 16, v232
  v_accvgpr_write_b32 a255, v232
  v_accvgpr_write_b32 a251, v233
  s_waitcnt vmcnt(10)
  s_barrier
  ds_read_b64_tr_b16 a[4:5], v253 offset:20480
  ds_read_b64_tr_b16 a[6:7], v253 offset:22528
  ds_read_b64_tr_b16 v[32:33], v240 offset:4096
  ds_read_b64_tr_b16 v[34:35], v240 offset:6144
  ds_read_b64_tr_b16 v[36:37], v241 offset:4096
  ds_read_b64_tr_b16 v[38:39], v241 offset:6144
  ds_read_b64_tr_b16 v[40:41], v242 offset:4096
  ds_read_b64_tr_b16 v[42:43], v242 offset:6144
  ds_read_b64_tr_b16 v[44:45], v243 offset:4096
  ds_read_b64_tr_b16 v[46:47], v243 offset:6144
  s_waitcnt lgkmcnt(6)
  v_mfma_f32_16x16x32_bf16 v[20:23], a[4:7], v[32:35], v[20:23]
  s_waitcnt lgkmcnt(4)
  s_add_u32 m0, s37, 139264
  v_mfma_f32_16x16x32_bf16 v[24:27], a[4:7], v[36:39], v[24:27]
  s_waitcnt lgkmcnt(2)
  buffer_load_dwordx4 v248, s[20:23], s70 offen lds
  v_mfma_f32_16x16x32_bf16 v[28:31], a[4:7], v[40:43], v[28:31]
  s_waitcnt lgkmcnt(0)
  s_addk_i32 m0, -28672
  v_mfma_f32_16x16x32_bf16 v[0:3], a[4:7], v[44:47], v[0:3]
  buffer_load_dwordx4 v249, s[16:19], s81 offen nt lds
  s_add_u32 m0, s37, 40960
  s_nop 0
  buffer_load_dwordx4 v248, s[20:23], s71 offen lds
  s_add_u32 m0, s37, 114688
  s_nop 0
  buffer_load_dwordx4 v249, s[16:19], s82 offen nt lds
  s_add_u32 m0, s37, 45056
  s_nop 0
  buffer_load_dwordx4 v248, s[20:23], s72 offen lds
  s_waitcnt vmcnt(10)
  s_barrier
  ds_read_b64_tr_b16 a[8:9], v253 offset:24576
  ds_read_b64_tr_b16 a[10:11], v253 offset:26624
  ds_read_b64_tr_b16 v[48:49], v240 offset:8192
  ds_read_b64_tr_b16 v[50:51], v240 offset:10240
  ds_read_b64_tr_b16 v[52:53], v241 offset:8192
  ds_read_b64_tr_b16 v[54:55], v241 offset:10240
  ds_read_b64_tr_b16 v[56:57], v242 offset:8192
  ds_read_b64_tr_b16 v[58:59], v242 offset:10240
  ds_read_b64_tr_b16 v[60:61], v243 offset:8192
  ds_read_b64_tr_b16 v[62:63], v243 offset:10240
  ds_read_b64_tr_b16 a[12:13], v253 offset:28672
  ds_read_b64_tr_b16 a[14:15], v253 offset:30720
  ds_read_b64_tr_b16 v[64:65], v240 offset:12288
  ds_read_b64_tr_b16 v[66:67], v240 offset:14336
  s_waitcnt lgkmcnt(10)
  v_mfma_f32_16x16x32_bf16 v[20:23], a[8:11], v[48:51], v[20:23]
  s_waitcnt lgkmcnt(8)
  s_add_u32 m0, s37, 118784
  ds_read_b64_tr_b16 v[68:69], v241 offset:12288
  v_mfma_f32_16x16x32_bf16 v[24:27], a[8:11], v[52:55], v[24:27]
  s_waitcnt lgkmcnt(7)
  ds_read_b64_tr_b16 v[70:71], v241 offset:14336
  ds_read_b64_tr_b16 v[72:73], v242 offset:12288
  v_mfma_f32_16x16x32_bf16 v[28:31], a[8:11], v[56:59], v[28:31]
  s_waitcnt lgkmcnt(7)
  ds_read_b64_tr_b16 v[74:75], v242 offset:14336
  ds_read_b64_tr_b16 v[76:77], v243 offset:12288
  v_mfma_f32_16x16x32_bf16 v[0:3], a[8:11], v[60:63], v[0:3]
  s_waitcnt lgkmcnt(5)
  ds_read_b64_tr_b16 v[78:79], v243 offset:14336
  v_mfma_f32_16x16x32_bf16 v[20:23], a[12:15], v[64:67], v[20:23]
  s_waitcnt lgkmcnt(4)
  v_mfma_f32_16x16x32_bf16 v[24:27], a[12:15], v[68:71], v[24:27]
  s_waitcnt lgkmcnt(2)
  v_mfma_f32_16x16x32_bf16 v[28:31], a[12:15], v[72:75], v[28:31]
  s_waitcnt lgkmcnt(0)
  v_mfma_f32_16x16x32_bf16 v[0:3], a[12:15], v[76:79], v[0:3]
  buffer_load_dwordx4 v249, s[16:19], s83 offen nt lds
  s_addk_i32 m0, 24576
  s_nop 0
  buffer_load_dwordx4 v248, s[20:23], s73 offen lds
  s_add_u32 m0, s37, 49024
  s_nop 0
  buffer_load_dwordx4 v248, s[20:23], s64 offen offset:128 lds
  s_addk_i32 m0, 4096
  s_nop 0
  buffer_load_dwordx4 v248, s[20:23], s65 offen offset:128 lds
  s_mov_b64 exec, 0
  s_cmp_eq_u32 s36, 0
  s_cbranch_scc1 L_pg1
  s_cmp_eq_u32 s36, 1
  s_cbranch_scc1 L_pg2
  s_cmp_eq_u32 s36, 2
  s_cbranch_scc1 L_pg3
  s_branch L_pg4
L_ret:
  s_mov_b64 exec, -1
  s_waitcnt vmcnt(10)
  s_barrier
  ds_read_b64_tr_b16 a[16:17], v253 offset:32768
  ds_read_b64_tr_b16 a[18:19], v253 offset:34816
  ds_read_b64_tr_b16 v[80:81], v240 offset:16384
  ds_read_b64_tr_b16 v[82:83], v240 offset:18432
  ds_read_b64_tr_b16 v[84:85], v241 offset:16384
  ds_read_b64_tr_b16 v[86:87], v241 offset:18432
  ds_read_b64_tr_b16 v[88:89], v242 offset:16384
  ds_read_b64_tr_b16 v[90:91], v242 offset:18432
  ds_read_b64_tr_b16 v[92:93], v243 offset:16384
  ds_read_b64_tr_b16 v[94:95], v243 offset:18432
  ds_read_b64_tr_b16 a[20:21], v253 offset:36864
  ds_read_b64_tr_b16 a[22:23], v253 offset:38912
  ds_read_b64_tr_b16 v[96:97], v240 offset:20480
  ds_read_b64_tr_b16 v[98:99], v240 offset:22528
  s_waitcnt lgkmcnt(10)
  v_mfma_f32_16x16x32_bf16 v[20:23], a[16:19], v[80:83], v[20:23]
  s_waitcnt lgkmcnt(8)
  s_add_u32 m0, s37, 147328
  ds_read_b64_tr_b16 v[100:101], v241 offset:20480
  v_mfma_f32_16x16x32_bf16 v[24:27], a[16:19], v[84:87], v[24:27]
  s_waitcnt lgkmcnt(7)
  ds_read_b64_tr_b16 v[102:103], v241 offset:22528
  ds_read_b64_tr_b16 v[104:105], v242 offset:20480
  v_mfma_f32_16x16x32_bf16 v[28:31], a[16:19], v[88:91], v[28:31]
  s_waitcnt lgkmcnt(7)
  ds_read_b64_tr_b16 v[106:107], v242 offset:22528
  ds_read_b64_tr_b16 v[108:109], v243 offset:20480
  v_mfma_f32_16x16x32_bf16 v[0:3], a[16:19], v[92:95], v[0:3]
  s_waitcnt lgkmcnt(5)
  ds_read_b64_tr_b16 v[110:111], v243 offset:22528
  v_mfma_f32_16x16x32_bf16 v[20:23], a[20:23], v[96:99], v[20:23]
  s_waitcnt lgkmcnt(4)
  v_mfma_f32_16x16x32_bf16 v[24:27], a[20:23], v[100:103], v[24:27]
  s_waitcnt lgkmcnt(2)
  v_mfma_f32_16x16x32_bf16 v[28:31], a[20:23], v[104:107], v[28:31]
  s_waitcnt lgkmcnt(0)
  v_mfma_f32_16x16x32_bf16 v[0:3], a[20:23], v[108:111], v[0:3]
  ds_read_b128 v[112:115], v252 offset:64
  buffer_load_dwordx4 v248, s[20:23], s66 offen offset:128 lds
  s_addk_i32 m0, 4096
  s_nop 0
  buffer_load_dwordx4 v248, s[20:23], s67 offen offset:128 lds
  s_add_u32 m0, s37, 57216
  s_nop 0
  buffer_load_dwordx4 v248, s[20:23], s68 offen offset:128 lds
  s_addk_i32 m0, 4096
  s_nop 0
  buffer_load_dwordx4 v248, s[20:23], s69 offen offset:128 lds
  s_waitcnt vmcnt(10)
  s_barrier
  ds_read_b64_tr_b16 a[24:25], v253 offset:16384
  ds_read_b64_tr_b16 a[26:27], v253 offset:18432
  ds_read_b64_tr_b16 v[116:117], v240 offset:24576
  ds_read_b64_tr_b16 v[118:119], v240 offset:26624
  ds_read_b64_tr_b16 v[120:121], v241 offset:24576
  ds_read_b64_tr_b16 v[122:123], v241 offset:26624
  ds_read_b64_tr_b16 v[124:125], v242 offset:24576
  ds_read_b64_tr_b16 v[126:127], v242 offset:26624
  ds_read_b64_tr_b16 v[128:129], v243 offset:24576
  ds_read_b64_tr_b16 v[130:131], v243 offset:26624
  ds_read_b64_tr_b16 a[28:29], v251 offset:40960
  ds_read_b64_tr_b16 a[30:31], v251 offset:43008
  ds_read_b64_tr_b16 v[132:133], v240 offset:28672
  ds_read_b64_tr_b16 v[134:135], v240 offset:30720
  s_waitcnt lgkmcnt(10)
  v_mfma_f32_16x16x32_bf16 v[20:23], a[24:27], v[116:119], v[20:23]
  s_waitcnt lgkmcnt(8)
  s_add_u32 m0, s37, 155520
  ds_read_b64_tr_b16 v[136:137], v241 offset:28672
  v_mfma_f32_16x16x32_bf16 v[24:27], a[24:27], v[120:123], v[24:27]
  s_waitcnt lgkmcnt(7)
  ds_read_b64_tr_b16 v[138:139], v241 offset:30720
  ds_read_b64_tr_b16 v[140:141], v242 offset:28672
  v_mfma_f32_16x16x32_bf16 v[28:31], a[24:27], v[124:127], v[28:31]
  s_waitcnt lgkmcnt(7)
  ds_read_b64_tr_b16 v[142:143], v242 offset:30720
  ds_read_b64_tr_b16 v[144:145], v243 offset:28672
  v_mfma_f32_16x16x32_bf16 v[0:3], a[24:27], v[128:131], v[0:3]
  s_waitcnt lgkmcnt(5)
  ds_read_b64_tr_b16 v[146:147], v243 offset:30720
  v_mfma_f32_16x16x32_bf16 v[20:23], a[28:31], v[132:135], v[20:23]
  s_waitcnt lgkmcnt(4)
  v_mfma_f32_16x16x32_bf16 v[24:27], a[28:31], v[136:139], v[24:27]
  s_waitcnt lgkmcnt(2)
  v_mfma_f32_16x16x32_bf16 v[28:31], a[28:31], v[140:143], v[28:31]
  s_waitcnt lgkmcnt(0)
  v_mfma_f32_16x16x32_bf16 v[0:3], a[28:31], v[144:147], v[0:3]
  buffer_load_dwordx4 v248, s[20:23], s70 offen offset:128 lds
  s_addk_i32 m0, 4096
  s_nop 0
  buffer_load_dwordx4 v248, s[20:23], s71 offen offset:128 lds
  s_waitcnt vmcnt(10)
  s_barrier
  ds_read_b64_tr_b16 a[32:33], v251 offset:45056
  ds_read_b64_tr_b16 a[34:35], v251 offset:47104
  ds_read_b64_tr_b16 v[148:149], v240 offset:32768
  ds_read_b64_tr_b16 v[150:151], v240 offset:34816
  ds_read_b64_tr_b16 v[152:153], v241 offset:32768
  ds_read_b64_tr_b16 v[154:155], v241 offset:34816
  ds_read_b64_tr_b16 v[156:157], v242 offset:32768
  ds_read_b64_tr_b16 v[158:159], v242 offset:34816
  ds_read_b64_tr_b16 v[160:161], v243 offset:32768
  ds_read_b64_tr_b16 v[162:163], v243 offset:34816
  s_waitcnt lgkmcnt(6)
  v_mfma_f32_16x16x32_bf16 v[20:23], a[32:35], v[148:151], v[20:23]
  s_waitcnt lgkmcnt(4)
  s_addk_i32 m0, -20480
  v_mfma_f32_16x16x32_bf16 v[24:27], a[32:35], v[152:155], v[24:27]
  s_waitcnt lgkmcnt(2)
  buffer_load_dwordx4 v248, s[20:23], s72 offen offset:128 lds
  v_mfma_f32_16x16x32_bf16 v[28:31], a[32:35], v[156:159], v[28:31]
  s_waitcnt lgkmcnt(0)
  s_add_u32 m0, s37, 40832
  v_mfma_f32_16x16x32_bf16 v[0:3], a[32:35], v[160:163], v[0:3]
  buffer_load_dwordx4 v248, s[20:23], s73 offen offset:128 lds
  s_waitcnt vmcnt(10)
  s_barrier
  ds_read_b64_tr_b16 a[36:37], v253 offset:20480
  ds_read_b64_tr_b16 a[38:39], v253 offset:22528
  ds_read_b64_tr_b16 v[164:165], v240 offset:36864
  ds_read_b64_tr_b16 v[166:167], v240 offset:38912
  ds_read_b64_tr_b16 v[168:169], v241 offset:36864
  ds_read_b64_tr_b16 v[170:171], v241 offset:38912
  ds_read_b64_tr_b16 v[172:173], v242 offset:36864
  ds_read_b64_tr_b16 v[174:175], v242 offset:38912
  ds_read_b64_tr_b16 v[176:177], v243 offset:36864
  ds_read_b64_tr_b16 v[178:179], v243 offset:38912
  ds_read2_b32 a[40:41], v254 offset0:0 offset1:32
  ds_read2_b32 a[42:43], v255 offset0:0 offset1:32
  s_waitcnt lgkmcnt(8)
  v_mfma_f32_16x16x32_bf16 v[20:23], a[36:39], v[164:167], v[20:23]
  s_waitcnt lgkmcnt(6)
  s_addk_i32 m0, 3968
  v_mfma_f32_16x16x32_bf16 v[24:27], a[36:39], v[168:171], v[24:27]
  s_waitcnt lgkmcnt(4)
  buffer_load_dwordx4 v248, s[20:23], s64 offen offset:256 lds
  v_mfma_f32_16x16x32_bf16 v[28:31], a[36:39], v[172:175], v[28:31]
  s_waitcnt lgkmcnt(2)
  s_addk_i32 m0, 20480
  ds_read2_b32 a[44:45], v254 offset0:1 offset1:33
  v_pk_mul_f32 v[20:21], v[20:21], s[48:49]
  v_pk_mul_f32 v[22:23], v[22:23], s[48:49]
  v_pk_mul_f32 v[24:25], v[24:25], s[48:49]
  v_pk_mul_f32 v[26:27], v[26:27], s[48:49]
  v_mfma_f32_16x16x32_bf16 v[0:3], a[36:39], v[176:179], v[0:3]
  ds_read2_b32 a[46:47], v255 offset0:1 offset1:33
  v_exp_f32 v224, v20
  buffer_load_dwordx4 v248, s[20:23], s65 offen offset:256 lds
  v_exp_f32 v225, v21
  v_exp_f32 v226, v22
  s_addk_i32 m0, 4096
  v_exp_f32 v227, v23
  v_exp_f32 v228, v24
  v_exp_f32 v229, v25
  v_exp_f32 v230, v26
  v_exp_f32 v231, v27
  v_pk_mul_f32 v[28:29], v[28:29], s[48:49]
  v_pk_mul_f32 v[30:31], v[30:31], s[48:49]
  v_pk_mul_f32 v[0:1], v[0:1], s[48:49]
  v_pk_mul_f32 v[2:3], v[2:3], s[48:49]
  v_pk_fma_f32 v[224:225], v[224:225], s[50:51], s[50:51]
  v_pk_fma_f32 v[226:227], v[226:227], s[50:51], s[50:51]
  v_pk_fma_f32 v[228:229], v[228:229], s[50:51], s[50:51]
  v_pk_fma_f32 v[230:231], v[230:231], s[50:51], s[50:51]
  buffer_load_dwordx4 v248, s[20:23], s66 offen offset:256 lds
  v_rcp_f32 v224, v224
  v_rcp_f32 v225, v225
  s_addk_i32 m0, 4096
  v_rcp_f32 v226, v226
  v_rcp_f32 v227, v227
  v_rcp_f32 v228, v228
  v_rcp_f32 v229, v229
  buffer_load_dwordx4 v248, s[20:23], s67 offen offset:256 lds
  v_rcp_f32 v230, v230
  v_rcp_f32 v231, v231
  s_addk_i32 m0, 4096
  v_exp_f32 v232, v28
  v_exp_f32 v233, v29
  v_exp_f32 v234, v30
  v_exp_f32 v235, v31
  buffer_load_dwordx4 v248, s[20:23], s68 offen offset:256 lds
  v_exp_f32 v236, v0
  v_exp_f32 v237, v1
  s_add_u32 m0, s37, 3840
  v_exp_f32 v238, v2
  v_exp_f32 v239, v3
  buffer_load_dwordx4 v248, s[20:23], s69 offen offset:256 lds
  s_addk_i32 m0, 4096
  s_nop 0
  buffer_load_dwordx4 v248, s[20:23], s70 offen offset:256 lds
  s_waitcnt vmcnt(8)
  s_barrier
  s_add_u32 m0, s37, 143104
  ds_read_b64_tr_b16 a[48:49], v251 offset:49152
  ds_read_b64_tr_b16 a[50:51], v251 offset:51200
  ds_read_b64_tr_b16 a[52:53], v251 offset:53248
  ds_read_b64_tr_b16 a[54:55], v251 offset:55296
  buffer_load_dwordx4 v248, s[20:23], s71 offen offset:256 lds
  s_add_u32 m0, s37, 12032
  ds_read_b64_tr_b16 a[56:57], v253 offset:24576
  ds_read_b64_tr_b16 a[58:59], v253 offset:26624
  ds_read_b64_tr_b16 a[60:61], v253 offset:28672
  ds_read_b64_tr_b16 a[62:63], v253 offset:30720
  ds_read_b64_tr_b16 a[64:65], v251 offset:57344
  ds_read_b64_tr_b16 a[66:67], v251 offset:59392
  ds_read_b64_tr_b16 a[68:69], v251 offset:61440
  ds_read_b64_tr_b16 a[70:71], v251 offset:63488
  s_waitcnt lgkmcnt(10)
  buffer_load_dwordx4 v248, s[20:23], s72 offen offset:256 lds
  s_addk_i32 m0, 4096
  ds_read_b64_tr_b16 a[72:73], v253 offset:32768
  ds_read_b64_tr_b16 a[74:75], v253 offset:34816
  ds_read_b64_tr_b16 a[76:77], v253 offset:36864
  ds_read_b64_tr_b16 a[78:79], v253 offset:38912
  v_mfma_f32_16x16x32_bf16 v[180:183], a[48:51], v[4:7], v[112:115]
  s_waitcnt lgkmcnt(12)
  ds_read_b64_tr_b16 a[80:81], v253 offset:16384
  ds_read_b64_tr_b16 a[82:83], v253 offset:18432
  v_mfma_f32_16x16x32_bf16 v[180:183], a[52:55], v[32:35], v[180:183]
  buffer_load_dwordx4 v248, s[20:23], s73 offen offset:256 lds
  v_mfma_f32_16x16x32_bf16 v[184:187], a[48:51], v[8:11], v[112:115]
  s_addk_i32 m0, 3968
  v_add_u32 v254, s32, v254
  v_add_u32 v255, s32, v255
  v_mfma_f32_16x16x32_bf16 v[184:187], a[52:55], v[36:39], v[184:187]
  ds_read2_b32 a[84:85], v254 offset0:0 offset1:32
  ds_read2_b32 a[86:87], v255 offset0:0 offset1:32
  v_mfma_f32_16x16x32_bf16 v[188:191], a[48:51], v[12:15], v[112:115]
  v_mfma_f32_16x16x32_bf16 v[188:191], a[52:55], v[40:43], v[188:191]
  v_mfma_f32_16x16x32_bf16 v[112:115], a[48:51], v[16:19], v[112:115]
  buffer_load_dwordx4 v248, s[20:23], s64 offen offset:384 lds
  v_mfma_f32_16x16x32_bf16 v[112:115], a[52:55], v[44:47], v[112:115]
  s_waitcnt lgkmcnt(7)
  s_addk_i32 m0, 4096
  ds_read2_b32 a[88:89], v254 offset0:1 offset1:33
  v_mfma_f32_16x16x32_bf16 v[180:183], a[56:59], v[48:51], v[180:183]
  v_mfma_f32_16x16x32_bf16 v[180:183], a[60:63], v[64:67], v[180:183]
  ds_read2_b32 a[90:91], v255 offset0:1 offset1:33
  v_mfma_f32_16x16x32_bf16 v[184:187], a[56:59], v[52:55], v[184:187]
  buffer_load_dwordx4 v248, s[20:23], s65 offen offset:384 lds
  v_mfma_f32_16x16x32_bf16 v[184:187], a[60:63], v[68:71], v[184:187]
  s_addk_i32 m0, 4096
  v_mfma_f32_16x16x32_bf16 v[188:191], a[56:59], v[56:59], v[188:191]
L_pg1:
  s_cbranch_execz L_pg5
  v_add_u32 v254, s33, v254
  v_add_u32 v255, s33, v255
  v_mfma_f32_16x16x32_bf16 v[188:191], a[60:63], v[72:75], v[188:191]
  ds_read2_b32 a[92:93], v254 offset0:0 offset1:32
  v_mfma_f32_16x16x32_bf16 v[112:115], a[56:59], v[60:63], v[112:115]
  ds_read2_b32 a[94:95], v255 offset0:0 offset1:32
  v_mfma_f32_16x16x32_bf16 v[112:115], a[60:63], v[76:79], v[112:115]
  buffer_load_dwordx4 v248, s[20:23], s66 offen offset:384 lds
  v_mfma_f32_16x16x32_bf16 v[180:183], a[64:67], v[80:83], v[180:183]
  s_addk_i32 m0, 4096
  v_mfma_f32_16x16x32_bf16 v[180:183], a[68:71], v[96:99], v[180:183]
  ds_read2_b32 a[96:97], v254 offset0:1 offset1:33
  v_mfma_f32_16x16x32_bf16 v[184:187], a[64:67], v[84:87], v[184:187]
  v_mfma_f32_16x16x32_bf16 v[184:187], a[68:71], v[100:103], v[184:187]
  v_mfma_f32_16x16x32_bf16 v[188:191], a[64:67], v[88:91], v[188:191]
  buffer_load_dwordx4 v248, s[20:23], s67 offen offset:384 lds
  v_mfma_f32_16x16x32_bf16 v[188:191], a[68:71], v[104:107], v[188:191]
  s_addk_i32 m0, 4096
  ds_read2_b32 a[98:99], v255 offset0:1 offset1:33
  v_mfma_f32_16x16x32_bf16 v[112:115], a[64:67], v[92:95], v[112:115]
  v_mfma_f32_16x16x32_bf16 v[112:115], a[68:71], v[108:111], v[112:115]
  s_waitcnt lgkmcnt(4)
  ds_read_b128 v[192:195], v252 offset:128
  v_add_u32 v254, s34, v254
  v_add_u32 v255, s34, v255
  v_mfma_f32_16x16x32_bf16 v[180:183], a[72:75], v[116:119], v[180:183]
  buffer_load_dwordx4 v248, s[20:23], s68 offen offset:384 lds
  v_mfma_f32_16x16x32_bf16 v[180:183], a[76:79], v[132:135], v[180:183]
  s_waitcnt vmcnt(10)
  s_barrier
  v_mfma_f32_16x16x32_bf16 v[184:187], a[72:75], v[120:123], v[184:187]
  s_add_u32 m0, s37, 138880
  ds_read_b64_tr_b16 a[100:101], v251 offset:40960
  ds_read_b64_tr_b16 a[102:103], v251 offset:43008
  v_mfma_f32_16x16x32_bf16 v[184:187], a[76:79], v[136:139], v[184:187]
  buffer_load_dwordx4 v248, s[20:23], s69 offen offset:384 lds
  v_mfma_f32_16x16x32_bf16 v[188:191], a[72:75], v[124:127], v[188:191]
  s_addk_i32 m0, 8192
  ds_read2_b32 a[104:105], v254 offset0:0 offset1:32
  ds_read2_b32 a[106:107], v255 offset0:0 offset1:32
  v_mfma_f32_16x16x32_bf16 v[188:191], a[76:79], v[140:143], v[188:191]
  ds_read_b64_tr_b16 a[108:109], v251 offset:45056
  v_mfma_f32_16x16x32_bf16 v[112:115], a[72:75], v[128:131], v[112:115]
  buffer_load_dwordx4 v248, s[20:23], s70 offen offset:384 lds
  v_mfma_f32_16x16x32_bf16 v[112:115], a[76:79], v[144:147], v[112:115]
  s_addk_i32 m0, 4096
  ds_read_b64_tr_b16 a[110:111], v251 offset:47104
  ds_read_b64_tr_b16 a[112:113], v250 offset:49152
  v_mfma_f32_16x16x32_bf16 v[180:183], a[80:83], v[148:151], v[180:183]
  s_waitcnt lgkmcnt(5)
  ds_read_b64_tr_b16 a[114:115], v250 offset:51200
  ds_read2_b32 a[116:117], v254 offset0:1 offset1:33
  v_mfma_f32_16x16x32_bf16 v[180:183], a[100:103], v[164:167], v[180:183]
  v_mfma_f32_16x16x32_bf16 v[184:187], a[80:83], v[152:155], v[184:187]
  v_mfma_f32_16x16x32_bf16 v[184:187], a[100:103], v[168:171], v[184:187]
  buffer_load_dwordx4 v248, s[20:23], s71 offen offset:384 lds
  v_mfma_f32_16x16x32_bf16 v[188:191], a[80:83], v[156:159], v[188:191]
  s_addk_i32 m0, 4096
  ds_read2_b32 a[118:119], v255 offset0:1 offset1:33
  v_mul_f32 v20, v224, v20
  v_mfma_f32_16x16x32_bf16 v[188:191], a[100:103], v[172:175], v[188:191]
  ds_read_b64_tr_b16 a[120:121], v250 offset:53248
  v_mfma_f32_16x16x32_bf16 v[112:115], a[80:83], v[160:163], v[112:115]
  ds_read_b64_tr_b16 a[122:123], v250 offset:55296
  ds_read_b64_tr_b16 a[124:125], v250 offset:57344
  v_mfma_f32_16x16x32_bf16 v[112:115], a[100:103], v[176:179], v[112:115]
  buffer_load_dwordx4 v248, s[20:23], s72 offen offset:384 lds
  s_waitcnt lgkmcnt(7)
  s_addk_i32 m0, 4096
  v_mul_f32 v21, v225, v21
  v_mul_f32 v22, v226, v22
  v_mul_f32 v23, v227, v23
  v_mul_f32 v24, v228, v24
  v_mul_f32 v25, v229, v25
  v_mul_f32 v26, v230, v26
  v_mul_f32 v27, v231, v27
  v_cvt_pk_bf16_f32 v20, v20, v21
  v_cvt_pk_bf16_f32 v21, v22, v23
  v_cvt_pk_bf16_f32 v24, v24, v25
  v_cvt_pk_bf16_f32 v25, v26, v27
  v_fma_f32 v232, v232, s50, s50
  v_mfma_f32_16x16x32_bf16 v[196:199], a[108:111], v[4:7], v[192:195]
  s_waitcnt lgkmcnt(5)
  buffer_load_dwordx4 v248, s[20:23], s73 offen offset:384 lds
  v_mfma_f32_16x16x32_bf16 v[196:199], a[112:115], v[32:35], v[196:199]
  s_add_u32 m0, s37, 48640
  ds_read_b64_tr_b16 a[126:127], v250 offset:59392
  ds_read_b64_tr_b16 a[128:129], v250 offset:61440
  v_mfma_f32_16x16x32_bf16 v[200:203], a[108:111], v[8:11], v[192:195]
  v_fma_f32 v233, v233, s50, s50
  v_fma_f32 v234, v234, s50, s50
  v_mfma_f32_16x16x32_bf16 v[200:203], a[112:115], v[36:39], v[200:203]
  ds_read_b64_tr_b16 a[130:131], v250 offset:63488
  v_add_u32 v254, s35, v254
  v_add_u32 v255, s35, v255
  v_mfma_f32_16x16x32_bf16 v[204:207], a[108:111], v[12:15], v[192:195]
  buffer_load_dwordx4 v248, s[20:23], s64 offen offset:512 lds
  v_mfma_f32_16x16x32_bf16 v[204:207], a[112:115], v[40:43], v[204:207]
  s_addk_i32 m0, 4096
  ds_read2_b32 a[132:133], v254 offset0:0 offset1:32
  ds_read2_b32 a[134:135], v255 offset0:0 offset1:32
  v_mfma_f32_16x16x32_bf16 v[192:195], a[108:111], v[16:19], v[192:195]
  v_fma_f32 v235, v235, s50, s50
  v_fma_f32 v236, v236, s50, s50
  v_mfma_f32_16x16x32_bf16 v[192:195], a[112:115], v[44:47], v[192:195]
  s_waitcnt lgkmcnt(5)
  v_fma_f32 v237, v237, s50, s50
  v_fma_f32 v238, v238, s50, s50
  v_mfma_f32_16x16x32_bf16 v[196:199], a[120:123], v[48:51], v[196:199]
  ds_read2_b32 a[136:137], v254 offset0:1 offset1:33
  v_fma_f32 v239, v239, s50, s50
  s_waitcnt lgkmcnt(5)
  buffer_load_dwordx4 v248, s[20:23], s65 offen offset:512 lds
  v_mul_f32 v180, s48, v180
  v_mul_f32 v181, s48, v181
  v_mul_f32 v182, s48, v182
  v_mul_f32 v183, s48, v183
  s_addk_i32 m0, 4096
  ds_read2_b32 a[138:139], v255 offset0:1 offset1:33
  v_mul_f32 v184, s48, v184
  v_mul_f32 v185, s48, v185
  v_mul_f32 v186, s48, v186
  v_mul_f32 v187, s48, v187
  v_mfma_f32_16x16x32_bf16 v[196:199], a[124:127], v[64:67], v[196:199]
  v_rcp_f32 v232, v232
  v_mfma_f32_16x16x32_bf16 v[200:203], a[120:123], v[52:55], v[200:203]
  buffer_load_dwordx4 v248, s[20:23], s66 offen offset:512 lds
  v_mfma_f32_16x16x32_bf16 v[200:203], a[124:127], v[68:71], v[200:203]
  s_addk_i32 m0, 4096
  v_rcp_f32 v233, v233
  v_mfma_f32_16x16x32_bf16 v[204:207], a[120:123], v[56:59], v[204:207]
  v_rcp_f32 v234, v234
  v_mfma_f32_16x16x32_bf16 v[204:207], a[124:127], v[72:75], v[204:207]
  v_rcp_f32 v235, v235
  v_mfma_f32_16x16x32_bf16 v[192:195], a[120:123], v[60:63], v[192:195]
  v_rcp_f32 v236, v236
  v_mfma_f32_16x16x32_bf16 v[192:195], a[124:127], v[76:79], v[192:195]
  s_waitcnt lgkmcnt(3)
  buffer_load_dwordx4 v248, s[20:23], s67 offen offset:512 lds
  v_mfma_f32_16x16x32_bf16 v[196:199], a[128:131], v[80:83], v[196:199]
  s_waitcnt vmcnt(9)
  s_barrier
  s_addk_i32 m0, -20480
  ds_read_b64_tr_b16 a[140:141], v251 offset:4096
  ds_read_b64_tr_b16 a[142:143], v251 offset:6144
  ds_read_b64_tr_b16 a[144:145], v251 offset:8192
  ds_read_b64_tr_b16 a[146:147], v251 offset:10240
  v_rcp_f32 v237, v237
  v_rcp_f32 v238, v238
  buffer_load_dwordx4 v248, s[20:23], s68 offen offset:512 lds
  v_rcp_f32 v239, v239
  v_exp_f32 v224, v180
  s_addk_i32 m0, 4096
  ds_read_b64_tr_b16 a[148:149], v253 offset:20480
  ds_read_b64_tr_b16 a[150:151], v253 offset:22528
  ds_read_b64_tr_b16 a[152:153], v251 offset:12288
  ds_read_b64_tr_b16 a[154:155], v251 offset:14336
  v_exp_f32 v225, v181
  v_exp_f32 v226, v182
  s_waitcnt lgkmcnt(6)
  buffer_load_dwordx4 v248, s[20:23], s69 offen offset:512 lds
  v_exp_f32 v227, v183
  v_exp_f32 v228, v184
  v_mfma_f32_16x16x32_bf16 v[196:199], a[140:143], v[96:99], v[196:199]
  s_addk_i32 m0, 20480
  ds_read_b64_tr_b16 a[156:157], v251 offset:16384
  ds_read_b64_tr_b16 a[158:159], v251 offset:18432
  v_mfma_f32_16x16x32_bf16 v[200:203], a[128:131], v[84:87], v[200:203]
  ds_read_b64_tr_b16 a[160:161], v251 offset:20480
  ds_read_b64_tr_b16 a[162:163], v251 offset:22528
  v_mfma_f32_16x16x32_bf16 v[200:203], a[140:143], v[100:103], v[200:203]
  buffer_load_dwordx4 v248, s[20:23], s70 offen offset:512 lds
  v_mfma_f32_16x16x32_bf16 v[204:207], a[128:131], v[88:91], v[204:207]
  s_addk_i32 m0, 4096
  ds_read_b64_tr_b16 a[164:165], v251 offset:24576
  ds_read_b64_tr_b16 a[166:167], v251 offset:26624
  v_mfma_f32_16x16x32_bf16 v[204:207], a[140:143], v[104:107], v[204:207]
  ds_read_b64_tr_b16 a[168:169], v251 offset:28672
  ds_read_b64_tr_b16 a[170:171], v251 offset:30720
  v_mfma_f32_16x16x32_bf16 v[192:195], a[128:131], v[92:95], v[192:195]
  ds_read_b64_tr_b16 a[172:173], v251 offset:32768
  ds_read_b64_tr_b16 a[174:175], v251 offset:34816
  v_mfma_f32_16x16x32_bf16 v[192:195], a[140:143], v[108:111], v[192:195]
  s_waitcnt lgkmcnt(10)
  buffer_load_dwordx4 v248, s[20:23], s71 offen offset:512 lds
  v_mfma_f32_16x16x32_bf16 v[196:199], a[144:147], v[116:119], v[196:199]
  s_addk_i32 m0, 4096
  ds_read_b128 v[208:211], v252 offset:192
  ds_read_b64_tr_b16 a[176:177], v251 offset:36864
  v_mfma_f32_16x16x32_bf16 v[196:199], a[148:151], v[132:135], v[196:199]
  ds_read_b64_tr_b16 a[178:179], v251 offset:38912
  v_exp_f32 v229, v185
  v_exp_f32 v230, v186
  v_exp_f32 v231, v187
  v_pk_mul_f32 v[28:29], v[28:29], v[232:233]
  v_pk_mul_f32 v[30:31], v[30:31], v[234:235]
  v_pk_mul_f32 v[0:1], v[0:1], v[236:237]
  v_pk_mul_f32 v[2:3], v[2:3], v[238:239]
  v_pk_mul_f32 v[188:189], v[188:189], s[48:49]
  v_pk_mul_f32 v[190:191], v[190:191], s[48:49]
  v_pk_mul_f32 v[112:113], v[112:113], s[48:49]
  v_pk_mul_f32 v[114:115], v[114:115], s[48:49]
  v_pk_fma_f32 v[224:225], v[224:225], s[50:51], s[50:51]
  v_pk_fma_f32 v[226:227], v[226:227], s[50:51], s[50:51]
  v_pk_fma_f32 v[228:229], v[228:229], s[50:51], s[50:51]
  v_pk_fma_f32 v[230:231], v[230:231], s[50:51], s[50:51]
  v_mfma_f32_16x16x32_bf16 v[200:203], a[144:147], v[120:123], v[200:203]
  buffer_load_dwordx4 v248, s[20:23], s72 offen offset:512 lds
  v_mfma_f32_16x16x32_bf16 v[200:203], a[148:151], v[136:139], v[200:203]
  s_addk_i32 m0, 4096
  v_rcp_f32 v224, v224
  v_mfma_f32_16x16x32_bf16 v[204:207], a[144:147], v[124:127], v[204:207]
  v_rcp_f32 v225, v225
  v_mfma_f32_16x16x32_bf16 v[204:207], a[148:151], v[140:143], v[204:207]
  v_cvt_pk_bf16_f32 v28, v28, v29
  v_cvt_pk_bf16_f32 v29, v30, v31
  v_mfma_f32_16x16x32_bf16 v[192:195], a[144:147], v[128:131], v[192:195]
  v_cvt_pk_bf16_f32 v0, v0, v1
  v_cvt_pk_bf16_f32 v1, v2, v3
  v_mfma_f32_16x16x32_bf16 v[192:195], a[148:151], v[144:147], v[192:195]
  buffer_load_dwordx4 v248, s[20:23], s73 offen offset:512 lds
  v_mfma_f32_16x16x32_bf16 v[196:199], a[152:155], v[148:151], v[196:199]
  s_waitcnt lgkmcnt(0)
  v_rcp_f32 v226, v226
  v_mfma_f32_16x16x32_bf16 v[196:199], a[156:159], v[164:167], v[196:199]
  v_rcp_f32 v227, v227
  v_mfma_f32_16x16x32_bf16 v[200:203], a[152:155], v[152:155], v[200:203]
  v_rcp_f32 v228, v228
  v_mfma_f32_16x16x32_bf16 v[200:203], a[156:159], v[168:171], v[200:203]
  v_rcp_f32 v229, v229
  v_mfma_f32_16x16x32_bf16 v[204:207], a[152:155], v[156:159], v[204:207]
  s_mul_i32 s58, s44, 1664
  s_min_u32 s58, s58, 203136
  buffer_load_dword v247, v247, s[24:27], s58 offen
  v_mfma_f32_16x16x32_bf16 v[204:207], a[156:159], v[172:175], v[204:207]
  s_add_u32 m0, s37, 122752
  v_rcp_f32 v230, v230
  v_mfma_f32_16x16x32_bf16 v[192:195], a[152:155], v[160:163], v[192:195]
  v_rcp_f32 v231, v231
  v_mfma_f32_16x16x32_bf16 v[192:195], a[156:159], v[176:179], v[192:195]
  v_exp_f32 v232, v188
  v_mfma_f32_16x16x32_bf16 v[212:215], a[160:163], v[4:7], v[208:211]
  v_exp_f32 v233, v189
  v_mfma_f32_16x16x32_bf16 v[212:215], a[164:167], v[32:35], v[212:215]
  buffer_load_dwordx4 v249, s[16:19], s74 offen offset:128 nt lds
  v_mfma_f32_16x16x32_bf16 v[212:215], a[168:171], v[48:51], v[212:215]
  s_waitcnt vmcnt(8)
  s_barrier
  v_mfma_f32_16x16x32_bf16 v[212:215], a[172:175], v[64:67], v[212:215]
  s_add_u32 s64, s38, 0
  s_add_u32 m0, s37, 4096
  ds_read_b64_tr_b16 a[180:181], v253 offset:16384
  ds_read_b64_tr_b16 a[182:183], v253 offset:18432
  v_mfma_f32_16x16x32_bf16 v[212:215], a[176:179], v[80:83], v[212:215]
  buffer_load_dwordx4 v248, s[24:27], s64 offen lds
  v_mfma_f32_16x16x32_bf16 v[216:219], a[160:163], v[8:11], v[208:211]
  s_add_u32 m0, s37, 126848
  ds_read_b64_tr_b16 a[184:185], v253 offset:24576
  ds_read_b64_tr_b16 a[186:187], v253 offset:26624
  v_exp_f32 v234, v190
  v_exp_f32 v235, v191
  v_exp_f32 v236, v112
  v_exp_f32 v237, v113
  v_exp_f32 v238, v114
  v_exp_f32 v239, v115
  v_pk_mul_f32 v[180:181], v[180:181], v[224:225]
  v_pk_mul_f32 v[182:183], v[182:183], v[226:227]
  v_pk_mul_f32 v[184:185], v[184:185], v[228:229]
  v_pk_mul_f32 v[186:187], v[186:187], v[230:231]
  v_pk_mul_f32 v[196:197], v[196:197], s[48:49]
  v_pk_mul_f32 v[198:199], v[198:199], s[48:49]
  v_pk_mul_f32 v[200:201], v[200:201], s[48:49]
  v_pk_mul_f32 v[202:203], v[202:203], s[48:49]
  v_pk_fma_f32 v[232:233], v[232:233], s[50:51], s[50:51]
  v_pk_fma_f32 v[234:235], v[234:235], s[50:51], s[50:51]
  v_pk_fma_f32 v[236:237], v[236:237], s[50:51], s[50:51]
  v_pk_fma_f32 v[238:239], v[238:239], s[50:51], s[50:51]
  v_mfma_f32_16x16x32_bf16 v[216:219], a[164:167], v[36:39], v[216:219]
  buffer_load_dwordx4 v249, s[16:19], s75 offen offset:128 nt lds
  v_mfma_f32_16x16x32_bf16 v[216:219], a[168:171], v[52:55], v[216:219]
  s_add_u32 s65, s38, 10240
  s_add_u32 m0, s37, 8192
  ds_read_b64_tr_b16 a[188:189], v253 offset:28672
  ds_read_b64_tr_b16 a[190:191], v253 offset:30720
  v_rcp_f32 v232, v232
  v_mfma_f32_16x16x32_bf16 v[216:219], a[172:175], v[68:71], v[216:219]
  v_rcp_f32 v233, v233
  v_mfma_f32_16x16x32_bf16 v[216:219], a[176:179], v[84:87], v[216:219]
  ds_read_b64_tr_b16 a[192:193], v253 offset:32768
  ds_read_b64_tr_b16 a[194:195], v253 offset:34816
  buffer_load_dwordx4 v248, s[24:27], s65 offen lds
  v_cvt_pk_bf16_f32 v22, v180, v181
  v_cvt_pk_bf16_f32 v23, v182, v183
  v_cvt_pk_bf16_f32 v26, v184, v185
  v_cvt_pk_bf16_f32 v27, v186, v187
  v_mfma_f32_16x16x32_bf16 v[180:183], a[160:163], v[12:15], v[208:211]
  ds_write_b128 v220, v[20:23]
  v_mfma_f32_16x16x32_bf16 v[180:183], a[164:167], v[40:43], v[180:183]
  ds_write_b128 v221, v[24:27] offset:1024
  v_mfma_f32_16x16x32_bf16 v[180:183], a[168:171], v[56:59], v[180:183]
  s_add_u32 m0, s37, 130944
  v_rcp_f32 v234, v234
  v_mfma_f32_16x16x32_bf16 v[180:183], a[172:175], v[72:75], v[180:183]
  buffer_load_dwordx4 v249, s[16:19], s76 offen offset:128 nt lds
  v_mfma_f32_16x16x32_bf16 v[180:183], a[176:179], v[88:91], v[180:183]
  s_add_u32 s66, s38, 20480
  s_add_u32 m0, s37, 12288
  ds_read_b64_tr_b16 a[196:197], v253 offset:36864
  ds_read_b64_tr_b16 a[198:199], v253 offset:38912
  v_mfma_f32_16x16x32_bf16 v[208:211], a[160:163], v[16:19], v[208:211]
  v_rcp_f32 v235, v235
  v_mfma_f32_16x16x32_bf16 v[208:211], a[164:167], v[44:47], v[208:211]
  ds_read_b64_tr_b16 a[200:201], v251 offset:49152
  ds_read_b64_tr_b16 a[202:203], v251 offset:51200
  v_rcp_f32 v236, v236
  v_rcp_f32 v237, v237
  v_rcp_f32 v238, v238
  v_rcp_f32 v239, v239
  v_exp_f32 v224, v196
  v_exp_f32 v225, v197
  v_exp_f32 v226, v198
  v_exp_f32 v227, v199
  v_exp_f32 v228, v200
  v_exp_f32 v229, v201
  v_exp_f32 v230, v202
  v_exp_f32 v231, v203
  v_pk_mul_f32 v[188:189], v[188:189], v[232:233]
  v_pk_mul_f32 v[190:191], v[190:191], v[234:235]
  v_pk_mul_f32 v[112:113], v[112:113], v[236:237]
  v_pk_mul_f32 v[114:115], v[114:115], v[238:239]
  v_pk_mul_f32 v[204:205], v[204:205], s[48:49]
  v_pk_mul_f32 v[206:207], v[206:207], s[48:49]
  v_pk_mul_f32 v[192:193], v[192:193], s[48:49]
  v_pk_mul_f32 v[194:195], v[194:195], s[48:49]
  v_pk_fma_f32 v[224:225], v[224:225], s[50:51], s[50:51]
  v_pk_fma_f32 v[226:227], v[226:227], s[50:51], s[50:51]
  v_pk_fma_f32 v[228:229], v[228:229], s[50:51], s[50:51]
  v_pk_fma_f32 v[230:231], v[230:231], s[50:51], s[50:51]
  v_mfma_f32_16x16x32_bf16 v[208:211], a[168:171], v[60:63], v[208:211]
  buffer_load_dwordx4 v248, s[24:27], s66 offen lds
  v_mfma_f32_16x16x32_bf16 v[208:211], a[172:175], v[76:79], v[208:211]
  s_add_u32 m0, s37, 135040
  ds_read_b64_tr_b16 a[204:205], v251 offset:53248
  ds_read_b64_tr_b16 a[206:207], v251 offset:55296
  v_mfma_f32_16x16x32_bf16 v[208:211], a[176:179], v[92:95], v[208:211]
  s_waitcnt lgkmcnt(2)
  v_rcp_f32 v224, v224
  v_mfma_f32_16x16x32_bf16 v[212:215], a[180:183], v[96:99], v[212:215]
  ds_read_b64_tr_b16 a[208:209], v251 offset:57344
  ds_read_b64_tr_b16 a[210:211], v251 offset:59392
  v_mfma_f32_16x16x32_bf16 v[212:215], a[184:187], v[116:119], v[212:215]
  v_rcp_f32 v225, v225
  v_mfma_f32_16x16x32_bf16 v[212:215], a[188:191], v[132:135], v[212:215]
  buffer_load_dwordx4 v249, s[16:19], s77 offen offset:128 nt lds
  v_mfma_f32_16x16x32_bf16 v[212:215], a[192:195], v[148:151], v[212:215]
  s_add_u32 s67, s38, 30720
  s_add_u32 m0, s37, 16384
  ds_read_b128 v[184:187], v252 offset:256
  ds_read_b64_tr_b16 a[212:213], v251 offset:61440
  v_mfma_f32_16x16x32_bf16 v[212:215], a[196:199], v[164:167], v[212:215]
  v_cvt_pk_bf16_f32 v30, v188, v189
  v_cvt_pk_bf16_f32 v31, v190, v191
  v_mfma_f32_16x16x32_bf16 v[216:219], a[180:183], v[100:103], v[216:219]
  ds_write_b128 v222, v[28:31] offset:2048
  v_mfma_f32_16x16x32_bf16 v[216:219], a[184:187], v[120:123], v[216:219]
  s_waitcnt vmcnt(8) lgkmcnt(3)
  s_barrier
  v_cvt_pk_bf16_f32 v2, v112, v113
  v_mfma_f32_16x16x32_bf16 v[216:219], a[188:191], v[136:139], v[216:219]
  ds_read_b64_tr_b16 a[214:215], v251 offset:63488
  ds_read_b64_tr_b16 a[216:217], v251 offset:40960
  v_mfma_f32_16x16x32_bf16 v[216:219], a[192:195], v[152:155], v[216:219]
  v_cvt_pk_bf16_f32 v3, v114, v115
  v_rcp_f32 v226, v226
  v_mfma_f32_16x16x32_bf16 v[216:219], a[196:199], v[168:171], v[216:219]
  ds_write_b128 v223, v[0:3] offset:3072
  v_rcp_f32 v227, v227
  v_rcp_f32 v228, v228
  v_rcp_f32 v229, v229
  v_rcp_f32 v230, v230
  v_rcp_f32 v231, v231
  v_exp_f32 v232, v204
  v_exp_f32 v233, v205
  v_exp_f32 v234, v206
  v_exp_f32 v235, v207
  v_exp_f32 v236, v192
  v_exp_f32 v237, v193
  v_exp_f32 v238, v194
  v_exp_f32 v239, v195
  v_pk_mul_f32 v[196:197], v[196:197], v[224:225]
  v_pk_mul_f32 v[198:199], v[198:199], v[226:227]
  v_pk_mul_f32 v[200:201], v[200:201], v[228:229]
  v_pk_mul_f32 v[202:203], v[202:203], v[230:231]
  v_pk_mul_f32 v[212:213], v[212:213], s[48:49]
  v_pk_mul_f32 v[214:215], v[214:215], s[48:49]
  v_pk_mul_f32 v[216:217], v[216:217], s[48:49]
  v_pk_mul_f32 v[218:219], v[218:219], s[48:49]
  v_pk_fma_f32 v[232:233], v[232:233], s[50:51], s[50:51]
  v_pk_fma_f32 v[234:235], v[234:235], s[50:51], s[50:51]
  v_pk_fma_f32 v[236:237], v[236:237], s[50:51], s[50:51]
  v_pk_fma_f32 v[238:239], v[238:239], s[50:51], s[50:51]
  v_mfma_f32_16x16x32_bf16 v[180:183], a[180:183], v[104:107], v[180:183]
  buffer_load_dwordx4 v248, s[24:27], s67 offen lds
  v_mfma_f32_16x16x32_bf16 v[180:183], a[184:187], v[124:127], v[180:183]
  s_add_u32 m0, s37, 139136
  ds_read_b64_tr_b16 a[218:219], v251 offset:43008
  ds_read_b64_tr_b16 a[220:221], v251 offset:45056
  v_mfma_f32_16x16x32_bf16 v[180:183], a[188:191], v[140:143], v[180:183]
  v_rcp_f32 v232, v232
  v_mfma_f32_16x16x32_bf16 v[180:183], a[192:195], v[156:159], v[180:183]
  ds_read_b64_tr_b16 a[222:223], v251 offset:47104
  ds_read_b64_tr_b16 a[224:225], v250 offset:49152
  v_mfma_f32_16x16x32_bf16 v[180:183], a[196:199], v[172:175], v[180:183]
  v_rcp_f32 v233, v233
  v_mfma_f32_16x16x32_bf16 v[208:211], a[180:183], v[108:111], v[208:211]
  buffer_load_dwordx4 v249, s[16:19], s78 offen offset:128 nt lds
  v_mfma_f32_16x16x32_bf16 v[208:211], a[184:187], v[128:131], v[208:211]
  s_add_u32 s68, s38, 81920
  s_add_u32 m0, s37, 49152
  ds_read_b64_tr_b16 a[226:227], v250 offset:51200
  ds_read_b64_tr_b16 a[228:229], v250 offset:53248
  v_mfma_f32_16x16x32_bf16 v[208:211], a[188:191], v[144:147], v[208:211]
  v_cvt_pk_bf16_f32 v196, v196, v197
  v_cvt_pk_bf16_f32 v197, v198, v199
  v_mfma_f32_16x16x32_bf16 v[208:211], a[192:195], v[160:163], v[208:211]
  ds_read_b64_tr_b16 a[230:231], v250 offset:55296
  ds_read_b64_tr_b16 a[232:233], v250 offset:57344
  v_mfma_f32_16x16x32_bf16 v[208:211], a[196:199], v[176:179], v[208:211]
  s_waitcnt lgkmcnt(8)
  buffer_load_dwordx4 v248, s[24:27], s68 offen lds
  v_mfma_f32_16x16x32_bf16 v[20:23], a[200:203], v[4:7], v[184:187]
  s_add_u32 m0, s37, 143232
  ds_read_b64_tr_b16 a[234:235], v250 offset:59392
  ds_read_b64_tr_b16 a[236:237], v250 offset:61440
  v_mfma_f32_16x16x32_bf16 v[20:23], a[204:207], v[32:35], v[20:23]
  v_cvt_pk_bf16_f32 v200, v200, v201
  v_cvt_pk_bf16_f32 v201, v202, v203
  v_mfma_f32_16x16x32_bf16 v[20:23], a[208:211], v[48:51], v[20:23]
  ds_read_b64_tr_b16 a[238:239], v250 offset:63488
  v_rcp_f32 v234, v234
  v_mfma_f32_16x16x32_bf16 v[20:23], a[212:215], v[64:67], v[20:23]
  s_waitcnt lgkmcnt(7)
  v_rcp_f32 v235, v235
  v_mfma_f32_16x16x32_bf16 v[20:23], a[216:219], v[80:83], v[20:23]
  v_rcp_f32 v236, v236
  v_mfma_f32_16x16x32_bf16 v[24:27], a[200:203], v[8:11], v[184:187]
  v_rcp_f32 v237, v237
  v_mfma_f32_16x16x32_bf16 v[24:27], a[204:207], v[36:39], v[24:27]
  v_rcp_f32 v238, v238
  v_mfma_f32_16x16x32_bf16 v[24:27], a[208:211], v[52:55], v[24:27]
  v_rcp_f32 v239, v239
  v_mfma_f32_16x16x32_bf16 v[24:27], a[212:215], v[68:71], v[24:27]
  v_exp_f32 v224, v212
  v_mfma_f32_16x16x32_bf16 v[24:27], a[216:219], v[84:87], v[24:27]
  buffer_load_dwordx4 v249, s[16:19], s79 offen offset:128 nt lds
  v_mfma_f32_16x16x32_bf16 v[188:191], a[200:203], v[12:15], v[184:187]
  s_add_u32 s69, s38, 92160
  s_add_u32 m0, s37, 53248
  v_exp_f32 v225, v213
  v_mfma_f32_16x16x32_bf16 v[188:191], a[204:207], v[40:43], v[188:191]
  v_exp_f32 v226, v214
  v_mfma_f32_16x16x32_bf16 v[188:191], a[208:211], v[56:59], v[188:191]
  v_exp_f32 v227, v215
  v_mfma_f32_16x16x32_bf16 v[188:191], a[212:215], v[72:75], v[188:191]
  v_exp_f32 v228, v216
  v_mfma_f32_16x16x32_bf16 v[188:191], a[216:219], v[88:91], v[188:191]
  buffer_load_dwordx4 v248, s[24:27], s69 offen lds
  v_exp_f32 v229, v217
  v_exp_f32 v230, v218
  v_exp_f32 v231, v219
  v_pk_mul_f32 v[204:205], v[204:205], v[232:233]
  v_pk_mul_f32 v[206:207], v[206:207], v[234:235]
  v_pk_mul_f32 v[192:193], v[192:193], v[236:237]
  v_pk_mul_f32 v[194:195], v[194:195], v[238:239]
  v_pk_mul_f32 v[180:181], v[180:181], s[48:49]
  v_pk_mul_f32 v[182:183], v[182:183], s[48:49]
  v_pk_mul_f32 v[208:209], v[208:209], s[48:49]
  v_pk_mul_f32 v[210:211], v[210:211], s[48:49]
  v_pk_fma_f32 v[224:225], v[224:225], s[50:51], s[50:51]
  v_pk_fma_f32 v[226:227], v[226:227], s[50:51], s[50:51]
  v_pk_fma_f32 v[228:229], v[228:229], s[50:51], s[50:51]
  v_pk_fma_f32 v[230:231], v[230:231], s[50:51], s[50:51]
  v_mfma_f32_16x16x32_bf16 v[184:187], a[200:203], v[16:19], v[184:187]
  s_add_u32 m0, s37, 147328
  v_rcp_f32 v224, v224
  v_mfma_f32_16x16x32_bf16 v[184:187], a[204:207], v[44:47], v[184:187]
  v_rcp_f32 v225, v225
  v_mfma_f32_16x16x32_bf16 v[184:187], a[208:211], v[60:63], v[184:187]
  v_cvt_pk_bf16_f32 v204, v204, v205
  v_cvt_pk_bf16_f32 v205, v206, v207
  v_mfma_f32_16x16x32_bf16 v[184:187], a[212:215], v[76:79], v[184:187]
  v_cvt_pk_bf16_f32 v192, v192, v193
  v_cvt_pk_bf16_f32 v193, v194, v195
  v_mfma_f32_16x16x32_bf16 v[184:187], a[216:219], v[92:95], v[184:187]
  v_rcp_f32 v226, v226
  v_mfma_f32_16x16x32_bf16 v[20:23], a[220:223], v[96:99], v[20:23]
  s_waitcnt lgkmcnt(0)
  v_rcp_f32 v227, v227
  v_mfma_f32_16x16x32_bf16 v[20:23], a[224:227], v[116:119], v[20:23]
  v_rcp_f32 v228, v228
  v_mfma_f32_16x16x32_bf16 v[20:23], a[228:231], v[132:135], v[20:23]
  v_rcp_f32 v229, v229
  v_mfma_f32_16x16x32_bf16 v[20:23], a[232:235], v[148:151], v[20:23]
  ds_read_b128 v[28:31], v252
  v_rcp_f32 v230, v230
  v_mfma_f32_16x16x32_bf16 v[20:23], a[236:239], v[164:167], v[20:23]
  buffer_load_dwordx4 v249, s[16:19], s80 offen offset:128 nt lds
  v_mfma_f32_16x16x32_bf16 v[24:27], a[220:223], v[100:103], v[24:27]
  s_add_u32 s70, s38, 102400
  s_add_u32 m0, s37, 57344
  ds_read_b128 v[112:115], v252 offset:64
  v_mfma_f32_16x16x32_bf16 v[24:27], a[224:227], v[120:123], v[24:27]
  v_rcp_f32 v231, v231
  v_mfma_f32_16x16x32_bf16 v[24:27], a[228:231], v[136:139], v[24:27]
  s_waitcnt vmcnt(9)
  s_barrier
  v_mfma_f32_16x16x32_bf16 v[24:27], a[232:235], v[152:155], v[24:27]
  buffer_load_dwordx4 v248, s[24:27], s70 offen lds
  v_mfma_f32_16x16x32_bf16 v[24:27], a[236:239], v[168:171], v[24:27]
  s_add_u32 m0, s37, 151424
  ds_read_b128 v[0:3], v252 offset:128
  ds_read_b128 v[4:7], v252 offset:192
  v_mfma_f32_16x16x32_bf16 v[188:191], a[220:223], v[104:107], v[188:191]
  v_add_u32 v240, 40960, v240
  v_add_u32 v241, 40960, v241
  v_add_u32 v242, 40960, v242
  v_add_u32 v243, 40960, v243
  v_mfma_f32_16x16x32_bf16 v[188:191], a[224:227], v[124:127], v[188:191]
  ds_read_b64_tr_b16 v[32:33], v240
  ds_read_b64_tr_b16 v[34:35], v240 offset:2048
  v_mfma_f32_16x16x32_bf16 v[188:191], a[228:231], v[140:143], v[188:191]
  v_exp_f32 v232, v180
  v_mfma_f32_16x16x32_bf16 v[188:191], a[232:235], v[156:159], v[188:191]
  ds_read_b64_tr_b16 v[48:49], v240 offset:4096
  ds_read_b64_tr_b16 v[50:51], v240 offset:6144
  v_mfma_f32_16x16x32_bf16 v[188:191], a[236:239], v[172:175], v[188:191]
  v_exp_f32 v233, v181
  v_mfma_f32_16x16x32_bf16 v[184:187], a[220:223], v[108:111], v[184:187]
  ds_read_b128 v[64:67], v252 offset:256
  ds_read_b64_tr_b16 v[80:81], v241
  v_mfma_f32_16x16x32_bf16 v[184:187], a[224:227], v[128:131], v[184:187]
  v_exp_f32 v234, v182
  v_mfma_f32_16x16x32_bf16 v[184:187], a[228:231], v[144:147], v[184:187]
  ds_read_b64_tr_b16 v[82:83], v241 offset:2048
  ds_read_b64_tr_b16 v[8:9], v241 offset:4096
  v_mfma_f32_16x16x32_bf16 v[184:187], a[232:235], v[160:163], v[184:187]
  v_exp_f32 v235, v183
  v_mfma_f32_16x16x32_bf16 v[184:187], a[236:239], v[176:179], v[184:187]
  ds_read_b64_tr_b16 v[10:11], v241 offset:6144
  ds_read_b64_tr_b16 a[240:241], v251 offset:4096
  s_waitcnt lgkmcnt(8)
  ds_read_b64_tr_b16 a[242:243], v251 offset:6144
  ds_read_b64_tr_b16 v[36:37], v251 offset:8192
  ds_read_b64_tr_b16 v[38:39], v251 offset:10240
  v_accvgpr_read_b32 v252, a244
  v_exp_f32 v236, v208
  v_mfma_f32_16x16x32_bf16 v[52:55], a[0:3], v[32:35], v[28:31]
  s_waitcnt lgkmcnt(9)
  buffer_load_dwordx4 v249, s[16:19], s81 offen offset:128 nt lds
  s_add_u32 s71, s38, 112640
  s_add_u32 m0, s37, 40960
  v_xor_b32 v247, 48, v244
  v_mfma_f32_16x16x32_bf16 v[52:55], a[4:7], v[48:51], v[52:55]
  ds_read_b128 a[244:247], v244
  ds_read_b128 v[68:71], v244 offset:4096
  v_mfma_f32_16x16x32_bf16 v[84:87], a[48:51], v[32:35], v[112:115]
  ds_read_b128 v[12:15], v245
  v_exp_f32 v237, v209
  v_exp_f32 v238, v210
  v_exp_f32 v239, v211
  v_pk_mul_f32 v[212:213], v[212:213], v[224:225]
  v_pk_mul_f32 v[214:215], v[214:215], v[226:227]
  v_pk_mul_f32 v[216:217], v[216:217], v[228:229]
  v_pk_mul_f32 v[218:219], v[218:219], v[230:231]
  v_pk_mul_f32 v[20:21], v[20:21], s[48:49]
  v_pk_mul_f32 v[22:23], v[22:23], s[48:49]
  v_pk_mul_f32 v[24:25], v[24:25], s[48:49]
  v_pk_mul_f32 v[26:27], v[26:27], s[48:49]
  v_pk_fma_f32 v[232:233], v[232:233], s[50:51], s[50:51]
  v_pk_fma_f32 v[234:235], v[234:235], s[50:51], s[50:51]
  v_pk_fma_f32 v[236:237], v[236:237], s[50:51], s[50:51]
  v_pk_fma_f32 v[238:239], v[238:239], s[50:51], s[50:51]
  v_mfma_f32_16x16x32_bf16 v[84:87], a[52:55], v[48:51], v[84:87]
  buffer_load_dwordx4 v248, s[24:27], s71 offen lds
  v_mfma_f32_16x16x32_bf16 v[40:43], a[108:111], v[32:35], v[0:3]
  s_add_u32 m0, s37, 155520
  ds_read_b64_tr_b16 v[56:57], v242
  ds_read_b64_tr_b16 v[58:59], v242 offset:2048
  v_mfma_f32_16x16x32_bf16 v[40:43], a[112:115], v[48:51], v[40:43]
L_pg2:
  s_cbranch_execz L_ret
  v_rcp_f32 v232, v232
  v_mfma_f32_16x16x32_bf16 v[72:75], a[160:163], v[32:35], v[4:7]
  ds_read_b64_tr_b16 v[88:89], v242 offset:4096
  ds_read_b64_tr_b16 v[90:91], v242 offset:6144
  v_mfma_f32_16x16x32_bf16 v[72:75], a[164:167], v[48:51], v[72:75]
  s_waitcnt lgkmcnt(6)
  v_rcp_f32 v233, v233
  v_mfma_f32_16x16x32_bf16 v[16:19], a[200:203], v[32:35], v[64:67]
  ds_read_b128 v[44:47], v245 offset:4096
  ds_read_b128 v[60:63], v246
  v_mfma_f32_16x16x32_bf16 v[16:19], a[204:207], v[48:51], v[16:19]
  v_cvt_pk_bf16_f32 v198, v212, v213
  v_cvt_pk_bf16_f32 v199, v214, v215
  v_mfma_f32_16x16x32_bf16 v[76:79], a[0:3], v[80:83], v[28:31]
  ds_write_b128 v220, v[196:199] offset:16384
  v_mfma_f32_16x16x32_bf16 v[76:79], a[4:7], v[8:11], v[76:79]
  ds_read_b128 v[92:95], v246 offset:4096
  v_cvt_pk_bf16_f32 v202, v216, v217
  v_mfma_f32_16x16x32_bf16 v[96:99], a[48:51], v[80:83], v[112:115]
  buffer_load_dwordx4 v249, s[16:19], s82 offen offset:128 nt lds
  v_mfma_f32_16x16x32_bf16 v[96:99], a[52:55], v[8:11], v[96:99]
  s_mov_b32 s72, 163840
  s_add_u32 m0, s37, 45056
  ds_read_b64_tr_b16 v[116:117], v243
  ds_read_b64_tr_b16 v[118:119], v243 offset:2048
  v_mfma_f32_16x16x32_bf16 v[132:135], a[108:111], v[80:83], v[0:3]
  v_cvt_pk_bf16_f32 v203, v218, v219
  v_rcp_f32 v234, v234
  v_mfma_f32_16x16x32_bf16 v[132:135], a[112:115], v[8:11], v[132:135]
  ds_write_b128 v221, v[200:203] offset:17408
  v_mfma_f32_16x16x32_bf16 v[148:151], a[160:163], v[80:83], v[4:7]
  buffer_load_dwordx4 v248, s[24:27], s72 offen lds
  v_mfma_f32_16x16x32_bf16 v[148:151], a[164:167], v[8:11], v[148:151]
  s_add_u32 m0, s37, 159616
  ds_read_b64_tr_b16 v[164:165], v243 offset:4096
  ds_read_b64_tr_b16 v[166:167], v243 offset:6144
  v_mfma_f32_16x16x32_bf16 v[100:103], a[200:203], v[80:83], v[64:67]
  v_rcp_f32 v235, v235
  v_mfma_f32_16x16x32_bf16 v[100:103], a[204:207], v[8:11], v[100:103]
  s_waitcnt lgkmcnt(7)
  ds_read_b128 v[120:123], v247
  ds_read_b128 v[136:139], v247 offset:4096
  v_mfma_f32_16x16x32_bf16 v[152:155], a[0:3], v[56:59], v[28:31]
  v_rcp_f32 v236, v236
  v_mfma_f32_16x16x32_bf16 v[152:155], a[4:7], v[88:91], v[152:155]
  ds_read_b128 v[168:171], v244 offset:8192
  ds_read_b128 v[104:107], v244 offset:12288
  v_mfma_f32_16x16x32_bf16 v[124:127], a[48:51], v[56:59], v[112:115]
  s_waitcnt vmcnt(10)
  s_barrier
  v_mfma_f32_16x16x32_bf16 v[124:127], a[52:55], v[88:91], v[124:127]
  ds_read_b64_tr_b16 v[140:141], v240 offset:8192
  ds_read_b64_tr_b16 v[142:143], v240 offset:10240
  v_mfma_f32_16x16x32_bf16 v[156:159], a[108:111], v[56:59], v[0:3]
  v_rcp_f32 v237, v237
  v_mfma_f32_16x16x32_bf16 v[156:159], a[112:115], v[88:91], v[156:159]
  ds_read_b64_tr_b16 v[172:173], v240 offset:12288
  ds_read_b64_tr_b16 v[174:175], v240 offset:14336
  v_mfma_f32_16x16x32_bf16 v[108:111], a[160:163], v[56:59], v[4:7]
  v_rcp_f32 v238, v238
  v_mfma_f32_16x16x32_bf16 v[108:111], a[164:167], v[88:91], v[108:111]
  ds_read_b64_tr_b16 v[128:129], v251 offset:12288
  ds_read_b64_tr_b16 v[130:131], v251 offset:14336
  v_mfma_f32_16x16x32_bf16 v[144:147], a[200:203], v[56:59], v[64:67]
  v_rcp_f32 v239, v239
  v_mfma_f32_16x16x32_bf16 v[144:147], a[204:207], v[88:91], v[144:147]
  s_waitcnt lgkmcnt(9)
  buffer_load_dwordx4 v249, s[16:19], s83 offen offset:128 nt lds
  v_mfma_f32_16x16x32_bf16 v[28:31], a[0:3], v[116:119], v[28:31]
  s_mov_b32 s73, 184320
  s_add_u32 m0, s37, 61440
  ds_read_b64_tr_b16 a[0:1], v251 offset:16384
  ds_read_b64_tr_b16 a[2:3], v251 offset:18432
  v_mfma_f32_16x16x32_bf16 v[28:31], a[4:7], v[164:167], v[28:31]
  v_exp_f32 v224, v20
  v_mfma_f32_16x16x32_bf16 v[112:115], a[48:51], v[116:119], v[112:115]
  ds_read_b128 a[4:7], v245 offset:8192
  ds_read_b128 a[48:51], v245 offset:12288
  v_mfma_f32_16x16x32_bf16 v[112:115], a[52:55], v[164:167], v[112:115]
  buffer_load_dwordx4 v248, s[24:27], s73 offen lds
  v_mfma_f32_16x16x32_bf16 v[0:3], a[108:111], v[116:119], v[0:3]
  s_addk_i32 m0, 3968
  ds_read_b64_tr_b16 v[160:161], v241 offset:8192
  ds_read_b64_tr_b16 v[162:163], v241 offset:10240
  v_mfma_f32_16x16x32_bf16 v[0:3], a[112:115], v[164:167], v[0:3]
  v_exp_f32 v225, v21
  v_mfma_f32_16x16x32_bf16 v[4:7], a[160:163], v[116:119], v[4:7]
  ds_read_b64_tr_b16 v[176:177], v241 offset:12288
  ds_read_b64_tr_b16 v[178:179], v241 offset:14336
  v_mfma_f32_16x16x32_bf16 v[4:7], a[164:167], v[164:167], v[4:7]
  v_exp_f32 v226, v22
  v_mfma_f32_16x16x32_bf16 v[64:67], a[200:203], v[116:119], v[64:67]
  ds_read_b128 a[52:55], v246 offset:8192
  ds_read_b128 a[108:111], v246 offset:12288
  v_mfma_f32_16x16x32_bf16 v[64:67], a[204:207], v[164:167], v[64:67]
  s_waitcnt lgkmcnt(10)
  v_exp_f32 v227, v23
  v_mfma_f32_16x16x32_bf16 v[52:55], a[8:11], v[140:143], v[52:55]
  ds_read_b128 a[112:115], v247 offset:8192
  ds_read_b128 a[160:163], v247 offset:12288
  v_mfma_f32_16x16x32_bf16 v[52:55], a[12:15], v[172:175], v[52:55]
  v_exp_f32 v228, v24
  v_mfma_f32_16x16x32_bf16 v[84:87], a[56:59], v[140:143], v[84:87]
  v_exp_f32 v229, v25
  v_exp_f32 v230, v26
  v_exp_f32 v231, v27
  v_pk_mul_f32 v[180:181], v[180:181], v[232:233]
  v_pk_mul_f32 v[182:183], v[182:183], v[234:235]
  v_pk_mul_f32 v[208:209], v[208:209], v[236:237]
  v_pk_mul_f32 v[210:211], v[210:211], v[238:239]
  v_pk_mul_f32 v[188:189], v[188:189], s[48:49]
  v_pk_mul_f32 v[190:191], v[190:191], s[48:49]
  v_pk_mul_f32 v[184:185], v[184:185], s[48:49]
  v_pk_mul_f32 v[186:187], v[186:187], s[48:49]
  v_pk_fma_f32 v[224:225], v[224:225], s[50:51], s[50:51]
  v_pk_fma_f32 v[226:227], v[226:227], s[50:51], s[50:51]
  v_pk_fma_f32 v[228:229], v[228:229], s[50:51], s[50:51]
  v_pk_fma_f32 v[230:231], v[230:231], s[50:51], s[50:51]
  v_mfma_f32_16x16x32_bf16 v[84:87], a[60:63], v[172:175], v[84:87]
  ds_read_b64_tr_b16 v[32:33], v242 offset:8192
  ds_read_b64_tr_b16 v[34:35], v242 offset:10240
  v_mfma_f32_16x16x32_bf16 v[40:43], a[120:123], v[140:143], v[40:43]
  buffer_load_dwordx4 v248, s[24:27], s64 offen offset:128 lds
  v_mfma_f32_16x16x32_bf16 v[40:43], a[124:127], v[172:175], v[40:43]
  s_addk_i32 m0, 4096
  ds_read_b64_tr_b16 v[48:49], v242 offset:12288
  ds_read_b64_tr_b16 v[50:51], v242 offset:14336
  v_rcp_f32 v224, v224
  v_mfma_f32_16x16x32_bf16 v[72:75], a[168:171], v[140:143], v[72:75]
  v_rcp_f32 v225, v225
  v_mfma_f32_16x16x32_bf16 v[72:75], a[172:175], v[172:175], v[72:75]
  v_cvt_pk_bf16_f32 v206, v180, v181
  v_cvt_pk_bf16_f32 v207, v182, v183
  v_mfma_f32_16x16x32_bf16 v[16:19], a[208:211], v[140:143], v[16:19]
  ds_write_b128 v222, v[204:207] offset:18432
  v_mfma_f32_16x16x32_bf16 v[16:19], a[212:215], v[172:175], v[16:19]
  s_waitcnt lgkmcnt(5)
  buffer_load_dwordx4 v248, s[24:27], s65 offen offset:128 lds
  v_mfma_f32_16x16x32_bf16 v[76:79], a[8:11], v[160:163], v[76:79]
  s_addk_i32 m0, 4096
  v_cvt_pk_bf16_f32 v194, v208, v209
  v_cvt_pk_bf16_f32 v195, v210, v211
  v_mfma_f32_16x16x32_bf16 v[76:79], a[12:15], v[176:179], v[76:79]
  ds_write_b128 v223, v[192:195] offset:19456
  v_mfma_f32_16x16x32_bf16 v[96:99], a[56:59], v[160:163], v[96:99]
  v_rcp_f32 v226, v226
  v_mfma_f32_16x16x32_bf16 v[96:99], a[60:63], v[176:179], v[96:99]
  ds_read_b64_tr_b16 v[212:213], v243 offset:8192
  ds_read_b64_tr_b16 v[214:215], v243 offset:10240
  v_mfma_f32_16x16x32_bf16 v[132:135], a[120:123], v[160:163], v[132:135]
  v_rcp_f32 v227, v227
  v_mfma_f32_16x16x32_bf16 v[132:135], a[124:127], v[176:179], v[132:135]
  ds_read_b64_tr_b16 v[196:197], v243 offset:12288
  ds_read_b64_tr_b16 v[198:199], v243 offset:14336
  v_mfma_f32_16x16x32_bf16 v[148:151], a[168:171], v[160:163], v[148:151]
  v_rcp_f32 v228, v228
  v_mfma_f32_16x16x32_bf16 v[148:151], a[172:175], v[176:179], v[148:151]
  v_rcp_f32 v229, v229
  v_mfma_f32_16x16x32_bf16 v[100:103], a[208:211], v[160:163], v[100:103]
  v_rcp_f32 v230, v230
  v_mfma_f32_16x16x32_bf16 v[100:103], a[212:215], v[176:179], v[100:103]
  s_waitcnt lgkmcnt(5)
  v_rcp_f32 v231, v231
  v_mfma_f32_16x16x32_bf16 v[152:155], a[8:11], v[32:35], v[152:155]
  v_exp_f32 v232, v188
  v_mfma_f32_16x16x32_bf16 v[152:155], a[12:15], v[48:51], v[152:155]
  buffer_load_dwordx4 v248, s[24:27], s66 offen offset:128 lds
  v_mfma_f32_16x16x32_bf16 v[124:127], a[56:59], v[32:35], v[124:127]
  s_waitcnt vmcnt(9) lgkmcnt(4)
  s_barrier
  v_mfma_f32_16x16x32_bf16 v[124:127], a[60:63], v[48:51], v[124:127]
  s_addk_i32 m0, 4096
  ds_read_b64_tr_b16 v[216:217], v240 offset:16384
  ds_read_b64_tr_b16 v[218:219], v240 offset:18432
  v_mfma_f32_16x16x32_bf16 v[156:159], a[120:123], v[32:35], v[156:159]
  buffer_load_dwordx4 v248, s[24:27], s67 offen offset:128 lds
  v_mfma_f32_16x16x32_bf16 v[156:159], a[124:127], v[48:51], v[156:159]
  s_add_u32 m0, s37, 3968
  ds_read_b64_tr_b16 v[200:201], v240 offset:20480
  ds_read_b64_tr_b16 v[202:203], v240 offset:22528
  v_mfma_f32_16x16x32_bf16 v[108:111], a[168:171], v[32:35], v[108:111]
  v_exp_f32 v233, v189
  v_mfma_f32_16x16x32_bf16 v[108:111], a[172:175], v[48:51], v[108:111]
  ds_read_b64_tr_b16 a[164:165], v251 offset:49152
  ds_read_b64_tr_b16 a[166:167], v251 offset:51200
  v_mfma_f32_16x16x32_bf16 v[144:147], a[208:211], v[32:35], v[144:147]
  v_exp_f32 v234, v190
  v_mfma_f32_16x16x32_bf16 v[144:147], a[212:215], v[48:51], v[144:147]
  s_waitcnt lgkmcnt(6)
  ds_read_b128 a[200:203], v244 offset:16384
  ds_read_b64_tr_b16 a[204:205], v251 offset:53248
  v_mfma_f32_16x16x32_bf16 v[28:31], a[8:11], v[212:215], v[28:31]
  v_exp_f32 v235, v191
  v_mfma_f32_16x16x32_bf16 v[28:31], a[12:15], v[196:199], v[28:31]
  ds_read_b64_tr_b16 a[206:207], v251 offset:55296
  ds_read_b128 a[8:11], v244 offset:20480
  v_mfma_f32_16x16x32_bf16 v[112:115], a[56:59], v[212:215], v[112:115]
  v_exp_f32 v236, v184
  v_mfma_f32_16x16x32_bf16 v[112:115], a[60:63], v[196:199], v[112:115]
  ds_read_b64_tr_b16 v[80:81], v241 offset:16384
  ds_read_b64_tr_b16 v[82:83], v241 offset:18432
  v_mfma_f32_16x16x32_bf16 v[0:3], a[120:123], v[212:215], v[0:3]
  v_exp_f32 v237, v185
  v_mfma_f32_16x16x32_bf16 v[0:3], a[124:127], v[196:199], v[0:3]
  ds_read_b64_tr_b16 v[8:9], v241 offset:20480
  ds_read_b64_tr_b16 v[10:11], v241 offset:22528
  v_mfma_f32_16x16x32_bf16 v[4:7], a[168:171], v[212:215], v[4:7]
  v_exp_f32 v238, v186
  v_mfma_f32_16x16x32_bf16 v[4:7], a[172:175], v[196:199], v[4:7]
  ds_read_b128 a[12:15], v245 offset:16384
  ds_read_b128 a[56:59], v245 offset:20480
  v_mfma_f32_16x16x32_bf16 v[64:67], a[208:211], v[212:215], v[64:67]
  v_exp_f32 v239, v187
  v_mfma_f32_16x16x32_bf16 v[64:67], a[212:215], v[196:199], v[64:67]
  s_waitcnt lgkmcnt(10)
  buffer_load_dwordx4 v248, s[24:27], s68 offen offset:128 lds
  v_mfma_f32_16x16x32_bf16 v[52:55], a[16:19], v[216:219], v[52:55]
  s_addk_i32 m0, 4096
  ds_read_b128 a[60:63], v246 offset:16384
  ds_read_b128 a[120:123], v246 offset:20480
  v_mfma_f32_16x16x32_bf16 v[52:55], a[20:23], v[200:203], v[52:55]
  ds_read_b128 a[124:127], v247 offset:16384
  v_mfma_f32_16x16x32_bf16 v[84:87], a[64:67], v[216:219], v[84:87]
  ds_read_b128 a[168:171], v247 offset:20480
  v_mfma_f32_16x16x32_bf16 v[84:87], a[68:71], v[200:203], v[84:87]
  ds_read_b64_tr_b16 v[56:57], v242 offset:16384
  v_mfma_f32_16x16x32_bf16 v[40:43], a[128:131], v[216:219], v[40:43]
  buffer_load_dwordx4 v248, s[24:27], s69 offen offset:128 lds
  v_mfma_f32_16x16x32_bf16 v[40:43], a[140:143], v[200:203], v[40:43]
  s_addk_i32 m0, 4096
  ds_read_b64_tr_b16 v[58:59], v242 offset:18432
  ds_read_b64_tr_b16 v[88:89], v242 offset:20480
  v_mfma_f32_16x16x32_bf16 v[72:75], a[176:179], v[216:219], v[72:75]
  ds_read_b64_tr_b16 v[90:91], v242 offset:22528
  ds_read_b64_tr_b16 a[172:173], v251 offset:57344
  v_mfma_f32_16x16x32_bf16 v[72:75], a[180:183], v[200:203], v[72:75]
  ds_read_b64_tr_b16 a[174:175], v251 offset:59392
  ds_read_b128 a[208:211], v244 offset:24576
  v_mfma_f32_16x16x32_bf16 v[16:19], a[216:219], v[216:219], v[16:19]
  v_mfma_f32_16x16x32_bf16 v[16:19], a[220:223], v[200:203], v[16:19]
  s_waitcnt lgkmcnt(11)
  ds_read_b128 a[212:215], v244 offset:28672
  v_mfma_f32_16x16x32_bf16 v[76:79], a[16:19], v[80:83], v[76:79]
  ds_read_b128 v[116:119], v245 offset:24576
  v_mfma_f32_16x16x32_bf16 v[76:79], a[20:23], v[8:11], v[76:79]
  v_mul_f32 v20, v224, v20
  v_mul_f32 v21, v225, v21
  v_mfma_f32_16x16x32_bf16 v[96:99], a[64:67], v[80:83], v[96:99]
  ds_read_b128 v[164:167], v245 offset:28672
  v_mul_f32 v22, v226, v22
  v_mfma_f32_16x16x32_bf16 v[96:99], a[68:71], v[8:11], v[96:99]
  ds_read_b64_tr_b16 v[180:181], v243 offset:16384
  ds_read_b64_tr_b16 v[182:183], v243 offset:18432
  v_mfma_f32_16x16x32_bf16 v[132:135], a[128:131], v[80:83], v[132:135]
  v_mul_f32 v23, v227, v23
  v_mul_f32 v24, v228, v24
  v_mfma_f32_16x16x32_bf16 v[132:135], a[140:143], v[8:11], v[132:135]
  ds_read_b64_tr_b16 v[140:141], v243 offset:20480
  ds_read_b64_tr_b16 v[142:143], v243 offset:22528
  v_mfma_f32_16x16x32_bf16 v[148:151], a[176:179], v[80:83], v[148:151]
  v_mul_f32 v25, v229, v25
  v_mul_f32 v26, v230, v26
  v_mfma_f32_16x16x32_bf16 v[148:151], a[180:183], v[8:11], v[148:151]
  ds_read_b128 v[204:207], v246 offset:24576
  ds_read_b128 v[172:175], v246 offset:28672
  v_mfma_f32_16x16x32_bf16 v[100:103], a[216:219], v[80:83], v[100:103]
  v_mul_f32 v27, v231, v27
  v_add_u32 v220, s53, v220
  v_add_u32 v221, s53, v221
  v_add_u32 v222, s53, v222
  v_add_u32 v223, s53, v223
  v_cvt_pk_bf16_f32 v20, v20, v21
  v_mfma_f32_16x16x32_bf16 v[100:103], a[220:223], v[8:11], v[100:103]
  s_waitcnt lgkmcnt(9)
  buffer_load_dwordx4 v248, s[24:27], s70 offen offset:128 lds
  v_mfma_f32_16x16x32_bf16 v[152:155], a[16:19], v[56:59], v[152:155]
  s_addk_i32 m0, 4096
  ds_read_b128 v[208:211], v247 offset:24576
  ds_read_b128 v[192:195], v247 offset:28672
  v_mfma_f32_16x16x32_bf16 v[152:155], a[20:23], v[88:91], v[152:155]
  v_cvt_pk_bf16_f32 v21, v22, v23
  v_cvt_pk_bf16_f32 v24, v24, v25
  v_mfma_f32_16x16x32_bf16 v[124:127], a[64:67], v[56:59], v[124:127]
  ds_write_b64 v220, v[20:21] offset:32768
  v_mfma_f32_16x16x32_bf16 v[124:127], a[68:71], v[88:91], v[124:127]
  buffer_load_dwordx4 v248, s[24:27], s71 offen offset:128 lds
  v_mfma_f32_16x16x32_bf16 v[156:159], a[128:131], v[56:59], v[156:159]
  s_addk_i32 m0, 4096
  ds_read_b64_tr_b16 v[160:161], v240 offset:24576
  ds_read_b64_tr_b16 v[162:163], v240 offset:26624
  v_cvt_pk_bf16_f32 v25, v26, v27
  v_mfma_f32_16x16x32_bf16 v[156:159], a[140:143], v[88:91], v[156:159]
  ds_write_b64 v221, v[24:25] offset:33792
  v_mfma_f32_16x16x32_bf16 v[108:111], a[176:179], v[56:59], v[108:111]
  v_fma_f32 v232, v232, s50, s50
  v_fma_f32 v233, v233, s50, s50
  v_mfma_f32_16x16x32_bf16 v[108:111], a[180:183], v[88:91], v[108:111]
  buffer_load_dwordx4 v248, s[24:27], s72 offen offset:128 lds
  v_mfma_f32_16x16x32_bf16 v[144:147], a[216:219], v[56:59], v[144:147]
  s_addk_i32 m0, 4096
  ds_read_b64_tr_b16 v[176:177], v241 offset:24576
  ds_read_b64_tr_b16 v[178:179], v241 offset:26624
  v_mfma_f32_16x16x32_bf16 v[144:147], a[220:223], v[88:91], v[144:147]
  s_waitcnt lgkmcnt(8)
  v_fma_f32 v234, v234, s50, s50
  v_fma_f32 v235, v235, s50, s50
  v_mfma_f32_16x16x32_bf16 v[28:31], a[16:19], v[180:183], v[28:31]
  v_fma_f32 v236, v236, s50, s50
  v_fma_f32 v237, v237, s50, s50
  v_mfma_f32_16x16x32_bf16 v[28:31], a[20:23], v[140:143], v[28:31]
  v_fma_f32 v238, v238, s50, s50
  v_fma_f32 v239, v239, s50, s50
  v_mfma_f32_16x16x32_bf16 v[112:115], a[64:67], v[180:183], v[112:115]
  buffer_load_dwordx4 v248, s[24:27], s73 offen offset:128 lds
  v_mfma_f32_16x16x32_bf16 v[112:115], a[68:71], v[140:143], v[112:115]
  s_addk_i32 m0, 3968
  ds_read_b64_tr_b16 v[32:33], v242 offset:24576
  ds_read_b64_tr_b16 v[34:35], v242 offset:26624
  v_mfma_f32_16x16x32_bf16 v[0:3], a[128:131], v[180:183], v[0:3]
  v_rcp_f32 v232, v232
  v_mfma_f32_16x16x32_bf16 v[0:3], a[140:143], v[140:143], v[0:3]
  v_rcp_f32 v233, v233
  v_mfma_f32_16x16x32_bf16 v[4:7], a[176:179], v[180:183], v[4:7]
  v_rcp_f32 v234, v234
  v_mfma_f32_16x16x32_bf16 v[4:7], a[180:183], v[140:143], v[4:7]
  buffer_load_dwordx4 v248, s[24:27], s64 offen offset:256 lds
  v_mfma_f32_16x16x32_bf16 v[64:67], a[216:219], v[180:183], v[64:67]
  s_addk_i32 m0, 4096
  ds_read_b64_tr_b16 v[48:49], v243 offset:24576
  ds_read_b64_tr_b16 v[50:51], v243 offset:26624
  v_mfma_f32_16x16x32_bf16 v[64:67], a[220:223], v[140:143], v[64:67]
  s_waitcnt lgkmcnt(4)
  v_rcp_f32 v235, v235
  v_mfma_f32_16x16x32_bf16 v[52:55], a[24:27], v[160:163], v[52:55]
  v_rcp_f32 v236, v236
  v_mfma_f32_16x16x32_bf16 v[84:87], a[72:75], v[160:163], v[84:87]
  v_rcp_f32 v237, v237
  v_rcp_f32 v238, v238
  v_rcp_f32 v239, v239
  v_pk_mul_f32 v[188:189], v[188:189], v[232:233]
  v_pk_mul_f32 v[190:191], v[190:191], v[234:235]
  v_pk_mul_f32 v[184:185], v[184:185], v[236:237]
  v_pk_mul_f32 v[186:187], v[186:187], v[238:239]
  v_mfma_f32_16x16x32_bf16 v[40:43], a[144:147], v[160:163], v[40:43]
  s_waitcnt vmcnt(8)
  s_barrier
  v_mfma_f32_16x16x32_bf16 v[72:75], a[184:187], v[160:163], v[72:75]
  buffer_load_dwordx4 v248, s[24:27], s65 offen offset:256 lds
  v_mfma_f32_16x16x32_bf16 v[16:19], a[224:227], v[160:163], v[16:19]
  s_addk_i32 m0, 16384
  ds_read_b64_tr_b16 v[212:213], v240 offset:28672
  ds_read_b64_tr_b16 v[214:215], v240 offset:30720
  v_mfma_f32_16x16x32_bf16 v[76:79], a[24:27], v[176:179], v[76:79]
  ds_read_b64_tr_b16 v[196:197], v240 offset:32768
  ds_read_b64_tr_b16 v[198:199], v240 offset:34816
  v_mfma_f32_16x16x32_bf16 v[96:99], a[72:75], v[176:179], v[96:99]
  ds_read_b64_tr_b16 v[216:217], v241 offset:28672
  ds_read_b64_tr_b16 v[218:219], v241 offset:30720
  v_mfma_f32_16x16x32_bf16 v[132:135], a[144:147], v[176:179], v[132:135]
  ds_read_b64_tr_b16 v[200:201], v241 offset:32768
  ds_read_b64_tr_b16 v[202:203], v241 offset:34816
  v_mfma_f32_16x16x32_bf16 v[148:151], a[184:187], v[176:179], v[148:151]
  buffer_load_dwordx4 v248, s[24:27], s66 offen offset:256 lds
  v_mfma_f32_16x16x32_bf16 v[100:103], a[224:227], v[176:179], v[100:103]
  s_waitcnt lgkmcnt(8)
  s_addk_i32 m0, 4096
  ds_read_b64_tr_b16 v[80:81], v242 offset:28672
  ds_read_b64_tr_b16 v[82:83], v242 offset:30720
  v_mfma_f32_16x16x32_bf16 v[152:155], a[24:27], v[32:35], v[152:155]
  ds_read_b64_tr_b16 v[8:9], v242 offset:32768
  ds_read_b64_tr_b16 v[10:11], v242 offset:34816
  v_mfma_f32_16x16x32_bf16 v[124:127], a[72:75], v[32:35], v[124:127]
  ds_read_b64_tr_b16 v[20:21], v243 offset:28672
  ds_read_b64_tr_b16 v[22:23], v243 offset:30720
  v_mfma_f32_16x16x32_bf16 v[156:159], a[144:147], v[32:35], v[156:159]
  buffer_load_dwordx4 v248, s[24:27], s67 offen offset:256 lds
  v_mfma_f32_16x16x32_bf16 v[108:111], a[184:187], v[32:35], v[108:111]
  s_addk_i32 m0, 4096
  ds_read_b64_tr_b16 v[24:25], v243 offset:32768
  ds_read_b64_tr_b16 v[26:27], v243 offset:34816
  v_mfma_f32_16x16x32_bf16 v[144:147], a[224:227], v[32:35], v[144:147]
  ds_read_b64_tr_b16 v[56:57], v240 offset:36864
  ds_read_b64_tr_b16 v[58:59], v240 offset:38912
  v_mfma_f32_16x16x32_bf16 v[28:31], a[24:27], v[48:51], v[28:31]
  ds_read_b64_tr_b16 a[16:17], v241 offset:36864
  ds_read_b64_tr_b16 a[18:19], v241 offset:38912
  v_mfma_f32_16x16x32_bf16 v[112:115], a[72:75], v[48:51], v[112:115]
  ds_read_b64_tr_b16 a[20:21], v242 offset:36864
  ds_read_b64_tr_b16 a[22:23], v242 offset:38912
  v_mfma_f32_16x16x32_bf16 v[0:3], a[144:147], v[48:51], v[0:3]
  buffer_load_dwordx4 v248, s[24:27], s68 offen offset:256 lds
  v_mfma_f32_16x16x32_bf16 v[4:7], a[184:187], v[48:51], v[4:7]
  s_addk_i32 m0, -20480
  ds_read_b64_tr_b16 a[64:65], v243 offset:36864
  ds_read_b64_tr_b16 a[66:67], v243 offset:38912
  v_mfma_f32_16x16x32_bf16 v[64:67], a[224:227], v[48:51], v[64:67]
  s_waitcnt lgkmcnt(15)
  ds_read_b64_tr_b16 a[68:69], v251 offset:40960
  ds_read_b64_tr_b16 a[70:71], v251 offset:43008
  v_mfma_f32_16x16x32_bf16 v[52:55], a[28:31], v[212:215], v[52:55]
  ds_read_b64_tr_b16 a[128:129], v251 offset:45056
  ds_read_b64_tr_b16 a[130:131], v251 offset:47104
  v_mfma_f32_16x16x32_bf16 v[52:55], a[32:35], v[196:199], v[52:55]
  ds_read_b64_tr_b16 a[140:141], v251 offset:61440
  ds_read_b64_tr_b16 a[142:143], v251 offset:63488
  v_mfma_f32_16x16x32_bf16 v[76:79], a[28:31], v[216:219], v[76:79]
  buffer_load_dwordx4 v248, s[24:27], s69 offen offset:256 lds
  v_mfma_f32_16x16x32_bf16 v[76:79], a[32:35], v[200:203], v[76:79]
  s_waitcnt lgkmcnt(15)
  ds_read_b64_tr_b16 a[176:177], v250 offset:49152
  ds_read_b64_tr_b16 a[178:179], v250 offset:51200
  v_mfma_f32_16x16x32_bf16 v[152:155], a[28:31], v[80:83], v[152:155]
  ds_read_b64_tr_b16 a[180:181], v250 offset:53248
  ds_read_b64_tr_b16 a[182:183], v250 offset:55296
  v_mfma_f32_16x16x32_bf16 v[152:155], a[32:35], v[8:11], v[152:155]
  ds_read_b64_tr_b16 a[216:217], v250 offset:57344
  ds_read_b64_tr_b16 a[218:219], v250 offset:59392
  v_mfma_f32_16x16x32_bf16 v[28:31], a[28:31], v[20:23], v[28:31]
  s_waitcnt lgkmcnt(15)
  v_mfma_f32_16x16x32_bf16 v[28:31], a[32:35], v[24:27], v[28:31]
  v_mfma_f32_16x16x32_bf16 v[52:55], a[36:39], v[56:59], v[52:55]
  v_mfma_f32_16x16x32_bf16 v[76:79], a[36:39], a[16:19], v[76:79]
  s_waitcnt lgkmcnt(12)
  v_cvt_pk_bf16_f32 v188, v188, v189
  v_cvt_pk_bf16_f32 v189, v190, v191
  ds_write_b64 v222, v[188:189] offset:34816
  v_cvt_pk_bf16_f32 v184, v184, v185
  v_cvt_pk_bf16_f32 v185, v186, v187
  ds_write_b64 v223, v[184:185] offset:35840
  v_pk_mul_f32 v[52:53], v[52:53], s[48:49]
  v_pk_mul_f32 v[54:55], v[54:55], s[48:49]
  v_pk_mul_f32 v[76:77], v[76:77], s[48:49]
  v_pk_mul_f32 v[78:79], v[78:79], s[48:49]
  v_mfma_f32_16x16x32_bf16 v[152:155], a[36:39], a[20:23], v[152:155]
  s_waitcnt vmcnt(6) lgkmcnt(2)
  s_barrier
  v_mfma_f32_16x16x32_bf16 v[28:31], a[36:39], a[64:67], v[28:31]
  s_addk_i32 m0, 4096
  ds_read_b64_tr_b16 a[220:221], v250 offset:61440
  ds_read_b64_tr_b16 a[222:223], v250 offset:63488
  v_mfma_f32_16x16x32_bf16 v[84:87], a[76:79], v[212:215], v[84:87]
  buffer_load_dwordx4 v248, s[24:27], s70 offen offset:256 lds
  v_mfma_f32_16x16x32_bf16 v[84:87], a[80:83], v[196:199], v[84:87]
  s_addk_i32 m0, 4096
  ds_read_b64_tr_b16 a[24:25], v251 offset:4096
  ds_read_b64_tr_b16 a[26:27], v251 offset:6144
  v_mfma_f32_16x16x32_bf16 v[40:43], a[148:151], v[212:215], v[40:43]
  v_exp_f32 v224, v52
  v_mfma_f32_16x16x32_bf16 v[40:43], a[152:155], v[196:199], v[40:43]
  ds_read_b64_tr_b16 a[72:73], v251 offset:8192
  ds_read_b64_tr_b16 a[74:75], v251 offset:10240
  v_mfma_f32_16x16x32_bf16 v[96:99], a[76:79], v[216:219], v[96:99]
  v_exp_f32 v225, v53
  v_mfma_f32_16x16x32_bf16 v[96:99], a[80:83], v[200:203], v[96:99]
  buffer_load_dwordx4 v248, s[24:27], s71 offen offset:256 lds
  v_mfma_f32_16x16x32_bf16 v[132:135], a[148:151], v[216:219], v[132:135]
  s_addk_i32 m0, 16384
  ds_read_b64_tr_b16 a[144:145], v251 offset:12288
  ds_read_b64_tr_b16 a[146:147], v251 offset:14336
  v_mfma_f32_16x16x32_bf16 v[132:135], a[152:155], v[200:203], v[132:135]
  v_exp_f32 v226, v54
  v_mfma_f32_16x16x32_bf16 v[124:127], a[76:79], v[80:83], v[124:127]
  ds_read_b64_tr_b16 a[184:185], v251 offset:16384
  ds_read_b64_tr_b16 a[186:187], v251 offset:18432
  v_mfma_f32_16x16x32_bf16 v[124:127], a[80:83], v[8:11], v[124:127]
  v_exp_f32 v227, v55
  v_mfma_f32_16x16x32_bf16 v[156:159], a[148:151], v[80:83], v[156:159]
  buffer_load_dwordx4 v248, s[24:27], s72 offen offset:256 lds
  v_mfma_f32_16x16x32_bf16 v[156:159], a[152:155], v[8:11], v[156:159]
  s_addk_i32 m0, 4096
  ds_read_b64_tr_b16 a[224:225], v251 offset:20480
  ds_read_b64_tr_b16 a[226:227], v251 offset:22528
  v_mfma_f32_16x16x32_bf16 v[112:115], a[76:79], v[20:23], v[112:115]
  v_exp_f32 v228, v76
  v_mfma_f32_16x16x32_bf16 v[112:115], a[80:83], v[24:27], v[112:115]
  ds_read_b64_tr_b16 a[28:29], v251 offset:24576
  ds_read_b64_tr_b16 a[30:31], v251 offset:26624
  v_mfma_f32_16x16x32_bf16 v[0:3], a[148:151], v[20:23], v[0:3]
  v_exp_f32 v229, v77
  v_exp_f32 v230, v78
  v_exp_f32 v231, v79
  v_pk_mul_f32 v[152:153], v[152:153], s[48:49]
  v_pk_mul_f32 v[154:155], v[154:155], s[48:49]
  v_pk_mul_f32 v[28:29], v[28:29], s[48:49]
  v_pk_mul_f32 v[30:31], v[30:31], s[48:49]
  v_pk_fma_f32 v[224:225], v[224:225], s[50:51], s[50:51]
  v_pk_fma_f32 v[226:227], v[226:227], s[50:51], s[50:51]
  v_pk_fma_f32 v[228:229], v[228:229], s[50:51], s[50:51]
  v_pk_fma_f32 v[230:231], v[230:231], s[50:51], s[50:51]
  v_mfma_f32_16x16x32_bf16 v[0:3], a[152:155], v[24:27], v[0:3]
  buffer_load_dwordx4 v248, s[24:27], s73 offen offset:256 lds
  v_mfma_f32_16x16x32_bf16 v[84:87], a[100:103], v[56:59], v[84:87]
  s_addk_i32 m0, 3968
  v_rcp_f32 v224, v224
  v_mfma_f32_16x16x32_bf16 v[96:99], a[100:103], a[16:19], v[96:99]
  v_rcp_f32 v225, v225
  v_mfma_f32_16x16x32_bf16 v[124:127], a[100:103], a[20:23], v[124:127]
  v_rcp_f32 v226, v226
  v_mfma_f32_16x16x32_bf16 v[112:115], a[100:103], a[64:67], v[112:115]
  v_rcp_f32 v227, v227
  v_mfma_f32_16x16x32_bf16 v[40:43], a[156:159], v[56:59], v[40:43]
  buffer_load_dwordx4 v248, s[24:27], s64 offen offset:384 lds
  v_mfma_f32_16x16x32_bf16 v[132:135], a[156:159], a[16:19], v[132:135]
  s_addk_i32 m0, 4096
  v_rcp_f32 v228, v228
  v_mfma_f32_16x16x32_bf16 v[156:159], a[156:159], a[20:23], v[156:159]
  v_rcp_f32 v229, v229
  v_mfma_f32_16x16x32_bf16 v[0:3], a[156:159], a[64:67], v[0:3]
  v_rcp_f32 v230, v230
  v_mfma_f32_16x16x32_bf16 v[72:75], a[188:191], v[212:215], v[72:75]
  v_rcp_f32 v231, v231
  v_mfma_f32_16x16x32_bf16 v[72:75], a[192:195], v[196:199], v[72:75]
  buffer_load_dwordx4 v248, s[24:27], s65 offen offset:384 lds
  v_mfma_f32_16x16x32_bf16 v[16:19], a[228:231], v[212:215], v[16:19]
  s_waitcnt vmcnt(6) lgkmcnt(0)
  s_barrier
  v_mfma_f32_16x16x32_bf16 v[16:19], a[232:235], v[196:199], v[16:19]
  s_addk_i32 m0, 4096
  ds_read_b128 a[32:35], v244 offset:32768
  ds_read_b128 a[36:39], v244 offset:36864
  v_mfma_f32_16x16x32_bf16 v[148:151], a[188:191], v[216:219], v[148:151]
  buffer_load_dwordx4 v248, s[24:27], s66 offen offset:384 lds
  v_mfma_f32_16x16x32_bf16 v[148:151], a[192:195], v[200:203], v[148:151]
  s_add_u32 m0, s37, 3712
  ds_read_b128 a[76:79], v245 offset:32768
  ds_read_b128 a[80:83], v245 offset:36864
  v_mfma_f32_16x16x32_bf16 v[100:103], a[228:231], v[216:219], v[100:103]
  v_exp_f32 v232, v152
  v_mfma_f32_16x16x32_bf16 v[100:103], a[232:235], v[200:203], v[100:103]
  ds_read_b128 a[148:151], v246 offset:32768
  ds_read_b128 a[152:155], v246 offset:36864
  v_mfma_f32_16x16x32_bf16 v[108:111], a[188:191], v[80:83], v[108:111]
  v_exp_f32 v233, v153
  v_mfma_f32_16x16x32_bf16 v[108:111], a[192:195], v[8:11], v[108:111]
  buffer_load_dwordx4 v248, s[24:27], s67 offen offset:384 lds
  v_mfma_f32_16x16x32_bf16 v[144:147], a[228:231], v[80:83], v[144:147]
  s_addk_i32 m0, 4096
  ds_read_b128 a[100:103], v247 offset:32768
  ds_read_b128 a[156:159], v247 offset:36864
  v_mfma_f32_16x16x32_bf16 v[144:147], a[232:235], v[8:11], v[144:147]
  v_exp_f32 v234, v154
  v_mfma_f32_16x16x32_bf16 v[4:7], a[188:191], v[20:23], v[4:7]
  ds_read_b64_tr_b16 a[188:189], v251 offset:28672
  ds_read_b64_tr_b16 a[190:191], v251 offset:30720
  v_mfma_f32_16x16x32_bf16 v[4:7], a[192:195], v[24:27], v[4:7]
  v_exp_f32 v235, v155
  v_mfma_f32_16x16x32_bf16 v[64:67], a[228:231], v[20:23], v[64:67]
  buffer_load_dwordx4 v248, s[24:27], s68 offen offset:384 lds
  v_mfma_f32_16x16x32_bf16 v[64:67], a[232:235], v[24:27], v[64:67]
  s_addk_i32 m0, 4096
  ds_read_b64_tr_b16 a[192:193], v251 offset:32768
  ds_read_b64_tr_b16 a[194:195], v251 offset:34816
  v_mfma_f32_16x16x32_bf16 v[72:75], a[196:199], v[56:59], v[72:75]
  v_exp_f32 v236, v28
  v_mfma_f32_16x16x32_bf16 v[148:151], a[196:199], a[16:19], v[148:151]
  ds_read_b64_tr_b16 a[228:229], v251 offset:49152
  ds_read_b64_tr_b16 a[230:231], v251 offset:51200
  v_mfma_f32_16x16x32_bf16 v[108:111], a[196:199], a[20:23], v[108:111]
  ds_read_b64_tr_b16 a[232:233], v251 offset:53248
  ds_read_b64_tr_b16 a[234:235], v251 offset:55296
  v_mfma_f32_16x16x32_bf16 v[4:7], a[196:199], a[64:67], v[4:7]
  buffer_load_dwordx4 v248, s[24:27], s69 offen offset:384 lds
  v_mfma_f32_16x16x32_bf16 v[16:19], a[236:239], v[56:59], v[16:19]
  s_addk_i32 m0, 4096
  ds_read_b64_tr_b16 a[196:197], v251 offset:57344
  ds_read_b64_tr_b16 a[198:199], v251 offset:59392
  v_mfma_f32_16x16x32_bf16 v[100:103], a[236:239], a[16:19], v[100:103]
  ds_read_b64_tr_b16 a[16:17], v251 offset:36864
  ds_read_b64_tr_b16 a[18:19], v251 offset:38912
  v_mfma_f32_16x16x32_bf16 v[144:147], a[236:239], a[20:23], v[144:147]
  v_exp_f32 v237, v29
  v_exp_f32 v238, v30
  v_exp_f32 v239, v31
  v_pk_mul_f32 v[52:53], v[52:53], v[224:225]
  v_pk_mul_f32 v[54:55], v[54:55], v[226:227]
  v_pk_mul_f32 v[76:77], v[76:77], v[228:229]
  v_pk_mul_f32 v[78:79], v[78:79], v[230:231]
  v_pk_mul_f32 v[84:85], v[84:85], s[48:49]
  v_pk_mul_f32 v[86:87], v[86:87], s[48:49]
L_pg3:
  s_cbranch_execz L_ret
  v_pk_mul_f32 v[96:97], v[96:97], s[48:49]
  v_pk_mul_f32 v[98:99], v[98:99], s[48:49]
  v_pk_fma_f32 v[232:233], v[232:233], s[50:51], s[50:51]
  v_pk_fma_f32 v[234:235], v[234:235], s[50:51], s[50:51]
  v_pk_fma_f32 v[236:237], v[236:237], s[50:51], s[50:51]
  v_pk_fma_f32 v[238:239], v[238:239], s[50:51], s[50:51]
  v_mfma_f32_16x16x32_bf16 v[64:67], a[236:239], a[64:67], v[64:67]
  buffer_load_dwordx4 v248, s[24:27], s70 offen offset:384 lds
  v_mfma_f32_16x16x32_bf16 v[88:91], a[248:251], a[40:43], 0
  s_addk_i32 m0, 4096
  v_rcp_f32 v232, v232
  v_mfma_f32_16x16x32_bf16 v[88:91], a[240:243], a[244:247], v[88:91]
  v_rcp_f32 v233, v233
  v_mfma_f32_16x16x32_bf16 v[88:91], v[36:39], v[68:71], v[88:91]
  v_cvt_pk_bf16_f32 v52, v52, v53
  v_cvt_pk_bf16_f32 v53, v54, v55
  v_mfma_f32_16x16x32_bf16 v[180:183], a[252:255], a[40:43], 0
  v_cvt_pk_bf16_f32 v76, v76, v77
  v_cvt_pk_bf16_f32 v77, v78, v79
  v_mfma_f32_16x16x32_bf16 v[180:183], a[240:243], v[12:15], v[180:183]
  buffer_load_dwordx4 v248, s[24:27], s71 offen offset:384 lds
  v_mfma_f32_16x16x32_bf16 v[180:183], v[36:39], v[44:47], v[180:183]
  s_addk_i32 m0, 4096
  v_rcp_f32 v234, v234
  v_mfma_f32_16x16x32_bf16 v[140:143], a[248:251], a[44:47], 0
  v_rcp_f32 v235, v235
  v_mfma_f32_16x16x32_bf16 v[140:143], a[240:243], v[60:63], v[140:143]
  v_rcp_f32 v236, v236
  v_mfma_f32_16x16x32_bf16 v[140:143], v[36:39], v[92:95], v[140:143]
  v_rcp_f32 v237, v237
  v_mfma_f32_16x16x32_bf16 v[160:163], a[252:255], a[44:47], 0
  buffer_load_dwordx4 v248, s[24:27], s72 offen offset:384 lds
  v_mfma_f32_16x16x32_bf16 v[160:163], a[240:243], v[120:123], v[160:163]
  s_waitcnt vmcnt(8) lgkmcnt(0)
  s_barrier
  v_mfma_f32_16x16x32_bf16 v[160:163], v[36:39], v[136:139], v[160:163]
  s_add_u32 m0, s37, 56960
  ds_read_b64_tr_b16 a[20:21], v251 offset:40960
  ds_read_b64_tr_b16 a[22:23], v251 offset:43008
  v_mfma_f32_16x16x32_bf16 v[88:91], v[128:131], v[168:171], v[88:91]
  buffer_load_dwordx4 v248, s[24:27], s73 offen offset:384 lds
  v_mfma_f32_16x16x32_bf16 v[88:91], a[0:3], v[104:107], v[88:91]
  s_addk_i32 m0, -28800
  ds_read_b64_tr_b16 a[236:237], v251 offset:45056
  ds_read_b64_tr_b16 a[238:239], v251 offset:47104
  v_mfma_f32_16x16x32_bf16 v[180:183], v[128:131], a[4:7], v[180:183]
  v_rcp_f32 v238, v238
  v_mfma_f32_16x16x32_bf16 v[180:183], a[0:3], a[48:51], v[180:183]
  ds_read_b64_tr_b16 a[64:65], v251 offset:61440
  ds_read_b64_tr_b16 a[66:67], v251 offset:63488
  v_mfma_f32_16x16x32_bf16 v[140:143], v[128:131], a[52:55], v[140:143]
  v_rcp_f32 v239, v239
  v_mfma_f32_16x16x32_bf16 v[140:143], a[0:3], a[108:111], v[140:143]
  buffer_load_dwordx4 v248, s[24:27], s64 offen offset:512 lds
  v_mfma_f32_16x16x32_bf16 v[160:163], v[128:131], a[112:115], v[160:163]
  s_addk_i32 m0, 4096
  ds_read_b64_tr_b16 a[40:41], v250 offset:49152
  ds_read_b64_tr_b16 a[42:43], v250 offset:51200
  v_mfma_f32_16x16x32_bf16 v[160:163], a[0:3], a[160:163], v[160:163]
  v_exp_f32 v224, v84
  v_mfma_f32_16x16x32_bf16 v[88:91], a[164:167], a[200:203], v[88:91]
  ds_read_b64_tr_b16 a[44:45], v250 offset:53248
  ds_read_b64_tr_b16 a[46:47], v250 offset:55296
  v_mfma_f32_16x16x32_bf16 v[88:91], a[204:207], a[8:11], v[88:91]
  v_exp_f32 v225, v85
  v_mfma_f32_16x16x32_bf16 v[180:183], a[164:167], a[12:15], v[180:183]
  buffer_load_dwordx4 v248, s[24:27], s65 offen offset:512 lds
  v_mfma_f32_16x16x32_bf16 v[180:183], a[204:207], a[56:59], v[180:183]
  s_addk_i32 m0, 4096
  v_exp_f32 v226, v86
  v_mfma_f32_16x16x32_bf16 v[140:143], a[164:167], a[60:63], v[140:143]
  v_exp_f32 v227, v87
  v_mfma_f32_16x16x32_bf16 v[140:143], a[204:207], a[120:123], v[140:143]
  v_exp_f32 v228, v96
  v_mfma_f32_16x16x32_bf16 v[160:163], a[164:167], a[124:127], v[160:163]
  v_exp_f32 v229, v97
  v_exp_f32 v230, v98
  v_exp_f32 v231, v99
  v_pk_mul_f32 v[152:153], v[152:153], v[232:233]
  v_pk_mul_f32 v[154:155], v[154:155], v[234:235]
  v_pk_mul_f32 v[28:29], v[28:29], v[236:237]
  v_pk_mul_f32 v[30:31], v[30:31], v[238:239]
  v_pk_mul_f32 v[124:125], v[124:125], s[48:49]
  v_pk_mul_f32 v[126:127], v[126:127], s[48:49]
  v_pk_mul_f32 v[112:113], v[112:113], s[48:49]
  v_pk_mul_f32 v[114:115], v[114:115], s[48:49]
  v_pk_fma_f32 v[224:225], v[224:225], s[50:51], s[50:51]
  v_pk_fma_f32 v[226:227], v[226:227], s[50:51], s[50:51]
  v_pk_fma_f32 v[228:229], v[228:229], s[50:51], s[50:51]
  v_pk_fma_f32 v[230:231], v[230:231], s[50:51], s[50:51]
  v_mfma_f32_16x16x32_bf16 v[160:163], a[204:207], a[168:171], v[160:163]
  buffer_load_dwordx4 v248, s[24:27], s66 offen offset:512 lds
  v_mfma_f32_16x16x32_bf16 v[88:91], a[172:175], a[208:211], v[88:91]
  v_rcp_f32 v224, v224
  v_mfma_f32_16x16x32_bf16 v[88:91], a[68:71], a[212:215], v[88:91]
  v_rcp_f32 v225, v225
  v_mfma_f32_16x16x32_bf16 v[180:183], a[172:175], v[116:119], v[180:183]
  v_cvt_pk_bf16_f32 v152, v152, v153
  v_cvt_pk_bf16_f32 v153, v154, v155
  v_mfma_f32_16x16x32_bf16 v[180:183], a[68:71], v[164:167], v[180:183]
  v_cvt_pk_bf16_f32 v28, v28, v29
  v_cvt_pk_bf16_f32 v29, v30, v31
  v_mfma_f32_16x16x32_bf16 v[140:143], a[172:175], v[204:207], v[140:143]
  v_rcp_f32 v226, v226
  v_mfma_f32_16x16x32_bf16 v[140:143], a[68:71], v[172:175], v[140:143]
  v_rcp_f32 v227, v227
  v_mfma_f32_16x16x32_bf16 v[160:163], a[172:175], v[208:211], v[160:163]
  v_rcp_f32 v228, v228
  v_mfma_f32_16x16x32_bf16 v[160:163], a[68:71], v[192:195], v[160:163]
  v_rcp_f32 v229, v229
  v_mfma_f32_16x16x32_bf16 v[88:91], a[128:131], a[32:35], v[88:91]
  v_rcp_f32 v230, v230
  v_mfma_f32_16x16x32_bf16 v[88:91], a[140:143], a[36:39], v[88:91]
  s_waitcnt vmcnt(6) lgkmcnt(0)
  s_barrier
  v_mfma_f32_16x16x32_bf16 v[180:183], a[128:131], a[76:79], v[180:183]
  s_addk_i32 m0, 24576
  ds_read_b64_tr_b16 v[176:177], v250 offset:57344
  ds_read_b64_tr_b16 v[178:179], v250 offset:59392
  v_mfma_f32_16x16x32_bf16 v[180:183], a[140:143], a[80:83], v[180:183]
  buffer_load_dwordx4 v248, s[24:27], s67 offen offset:512 lds
  v_mfma_f32_16x16x32_bf16 v[140:143], a[128:131], a[148:151], v[140:143]
  s_addk_i32 m0, 4096
  ds_read_b64_tr_b16 v[32:33], v250 offset:61440
  ds_read_b64_tr_b16 v[34:35], v250 offset:63488
  v_mfma_f32_16x16x32_bf16 v[140:143], a[140:143], a[152:155], v[140:143]
  v_rcp_f32 v231, v231
  v_mfma_f32_16x16x32_bf16 v[160:163], a[128:131], a[100:103], v[160:163]
  ds_read_b64_tr_b16 v[240:241], v251 offset:4096
  ds_read_b64_tr_b16 v[242:243], v251 offset:6144
  v_mfma_f32_16x16x32_bf16 v[160:163], a[140:143], a[156:159], v[160:163]
  s_mov_b32 s86, 0
  v_cvt_pk_bf16_f32 v88, v88, v180
  v_cvt_pk_bf16_f32 v180, v89, v181
  v_mfma_f32_16x16x32_bf16 v[48:51], a[248:251], a[84:87], 0
  buffer_load_dwordx4 v248, s[24:27], s68 offen offset:512 lds
  v_mfma_f32_16x16x32_bf16 v[48:51], a[176:179], a[244:247], v[48:51]
  s_addk_i32 m0, 4096
  ds_read_b64_tr_b16 v[196:197], v251 offset:8192
  ds_read_b64_tr_b16 v[198:199], v251 offset:10240
  v_mfma_f32_16x16x32_bf16 v[48:51], a[180:183], v[68:71], v[48:51]
  v_cvt_pk_bf16_f32 v90, v90, v182
  v_cvt_pk_bf16_f32 v182, v91, v183
  v_mfma_f32_16x16x32_bf16 v[48:51], a[216:219], v[168:171], v[48:51]
  v_cvt_pk_bf16_f32 v89, v140, v160
  v_cvt_pk_bf16_f32 v181, v141, v161
  v_mfma_f32_16x16x32_bf16 v[48:51], a[220:223], v[104:107], v[48:51]
  v_cvt_pk_bf16_f32 v91, v142, v162
  v_cvt_pk_bf16_f32 v183, v143, v163
  v_mfma_f32_16x16x32_bf16 v[48:51], a[24:27], a[200:203], v[48:51]
  buffer_load_dwordx4 v248, s[24:27], s69 offen offset:512 lds
  v_mfma_f32_16x16x32_bf16 v[48:51], a[72:75], a[8:11], v[48:51]
  v_exp_f32 v232, v124
  v_mfma_f32_16x16x32_bf16 v[48:51], a[144:147], a[208:211], v[48:51]
  v_exp_f32 v233, v125
  v_mfma_f32_16x16x32_bf16 v[48:51], a[184:187], a[212:215], v[48:51]
  v_exp_f32 v234, v126
  v_mfma_f32_16x16x32_bf16 v[48:51], a[224:227], a[32:35], v[48:51]
  v_exp_f32 v235, v127
  v_mfma_f32_16x16x32_bf16 v[48:51], a[28:31], a[36:39], v[48:51]
  v_exp_f32 v236, v112
  v_mfma_f32_16x16x32_bf16 v[188:191], a[252:255], a[84:87], 0
  ds_read_b64_tr_b16 a[84:85], v251 offset:12288
  ds_read_b64_tr_b16 a[86:87], v251 offset:14336
  v_mfma_f32_16x16x32_bf16 v[188:191], a[176:179], v[12:15], v[188:191]
  buffer_store_dwordx2 v[88:89], v252, s[28:31], s86 offen sc1 nt
  v_mfma_f32_16x16x32_bf16 v[188:191], a[180:183], v[44:47], v[188:191]
  s_mov_b32 s86, 32768
  v_exp_f32 v237, v113
  v_exp_f32 v238, v114
  v_exp_f32 v239, v115
  v_pk_mul_f32 v[84:85], v[84:85], v[224:225]
  v_pk_mul_f32 v[86:87], v[86:87], v[226:227]
  v_pk_mul_f32 v[96:97], v[96:97], v[228:229]
  v_pk_mul_f32 v[98:99], v[98:99], v[230:231]
  v_pk_mul_f32 v[40:41], v[40:41], s[48:49]
  v_pk_mul_f32 v[42:43], v[42:43], s[48:49]
  v_pk_mul_f32 v[132:133], v[132:133], s[48:49]
  v_pk_mul_f32 v[134:135], v[134:135], s[48:49]
  v_pk_fma_f32 v[232:233], v[232:233], s[50:51], s[50:51]
  v_pk_fma_f32 v[234:235], v[234:235], s[50:51], s[50:51]
  v_pk_fma_f32 v[236:237], v[236:237], s[50:51], s[50:51]
  v_pk_fma_f32 v[238:239], v[238:239], s[50:51], s[50:51]
  v_mfma_f32_16x16x32_bf16 v[188:191], a[216:219], a[4:7], v[188:191]
  buffer_store_dwordx2 v[180:181], v252, s[28:31], s86 offen sc1 nt
  v_mfma_f32_16x16x32_bf16 v[188:191], a[220:223], a[48:51], v[188:191]
  s_mov_b32 s86, 65536
  v_rcp_f32 v232, v232
  v_mfma_f32_16x16x32_bf16 v[188:191], a[24:27], a[12:15], v[188:191]
  v_rcp_f32 v233, v233
  v_mfma_f32_16x16x32_bf16 v[188:191], a[72:75], a[56:59], v[188:191]
  v_add_u32 v220, s54, v220
  v_add_u32 v221, s54, v221
  v_add_u32 v222, s54, v222
  v_add_u32 v223, s54, v223
  v_cvt_pk_bf16_f32 v54, v84, v85
  v_cvt_pk_bf16_f32 v55, v86, v87
  v_mfma_f32_16x16x32_bf16 v[188:191], a[144:147], v[116:119], v[188:191]
  ds_write_b128 v220, v[52:55]
  v_mfma_f32_16x16x32_bf16 v[188:191], a[184:187], v[164:167], v[188:191]
  buffer_store_dwordx2 v[90:91], v252, s[28:31], s86 offen sc1 nt
  v_cvt_pk_bf16_f32 v78, v96, v97
  v_mfma_f32_16x16x32_bf16 v[188:191], a[224:227], a[76:79], v[188:191]
  s_mov_b32 s86, 98304
  ds_read_b64_tr_b16 v[216:217], v251 offset:16384
  ds_read_b64_tr_b16 v[218:219], v251 offset:18432
  v_mfma_f32_16x16x32_bf16 v[188:191], a[28:31], a[80:83], v[188:191]
  s_waitcnt vmcnt(6) lgkmcnt(3)
  s_barrier
  v_cvt_pk_bf16_f32 v79, v98, v99
  v_mfma_f32_16x16x32_bf16 v[184:187], a[248:251], a[88:91], 0
  ds_write_b128 v221, v[76:79] offset:1024
  v_mfma_f32_16x16x32_bf16 v[184:187], a[176:179], v[60:63], v[184:187]
  s_addk_i32 m0, 4096
  ds_read_b64_tr_b16 v[200:201], v251 offset:20480
  ds_read_b64_tr_b16 v[202:203], v251 offset:22528
  v_mfma_f32_16x16x32_bf16 v[184:187], a[180:183], v[92:95], v[184:187]
  buffer_load_dwordx4 v248, s[24:27], s70 offen offset:512 lds
  v_mfma_f32_16x16x32_bf16 v[184:187], a[216:219], a[52:55], v[184:187]
  s_addk_i32 m0, 4096
  ds_read_b64_tr_b16 v[80:81], v251 offset:24576
  ds_read_b64_tr_b16 v[82:83], v251 offset:26624
  v_mfma_f32_16x16x32_bf16 v[184:187], a[220:223], a[108:111], v[184:187]
  v_cvt_pk_bf16_f32 v48, v48, v188
  v_cvt_pk_bf16_f32 v188, v49, v189
  v_mfma_f32_16x16x32_bf16 v[184:187], a[24:27], a[60:63], v[184:187]
  ds_read_b64_tr_b16 v[8:9], v251 offset:57344
  ds_read_b64_tr_b16 v[10:11], v251 offset:59392
  v_mfma_f32_16x16x32_bf16 v[184:187], a[72:75], a[120:123], v[184:187]
  v_cvt_pk_bf16_f32 v50, v50, v190
  v_cvt_pk_bf16_f32 v190, v51, v191
  v_mfma_f32_16x16x32_bf16 v[184:187], a[144:147], v[204:207], v[184:187]
  buffer_load_dwordx4 v248, s[24:27], s71 offen offset:512 lds
  v_mfma_f32_16x16x32_bf16 v[184:187], a[184:187], v[172:175], v[184:187]
  s_add_u32 m0, s37, 3584
  v_rcp_f32 v234, v234
  v_mfma_f32_16x16x32_bf16 v[184:187], a[224:227], a[148:151], v[184:187]
  v_rcp_f32 v235, v235
  v_mfma_f32_16x16x32_bf16 v[184:187], a[28:31], a[152:155], v[184:187]
  v_rcp_f32 v236, v236
  v_mfma_f32_16x16x32_bf16 v[212:215], a[252:255], a[88:91], 0
  ds_read_b64_tr_b16 a[88:89], v251 offset:28672
  ds_read_b64_tr_b16 a[90:91], v251 offset:30720
  v_mfma_f32_16x16x32_bf16 v[212:215], a[176:179], v[120:123], v[212:215]
  buffer_load_dwordx4 v248, s[24:27], s72 offen offset:512 lds
  v_mfma_f32_16x16x32_bf16 v[212:215], a[180:183], v[136:139], v[212:215]
  s_addk_i32 m0, 4096
  v_rcp_f32 v237, v237
  v_mfma_f32_16x16x32_bf16 v[212:215], a[216:219], a[112:115], v[212:215]
  v_rcp_f32 v238, v238
  v_mfma_f32_16x16x32_bf16 v[212:215], a[220:223], a[160:163], v[212:215]
  v_rcp_f32 v239, v239
  v_mfma_f32_16x16x32_bf16 v[212:215], a[24:27], a[124:127], v[212:215]
  v_exp_f32 v224, v40
  v_mfma_f32_16x16x32_bf16 v[212:215], a[72:75], a[168:171], v[212:215]
  buffer_load_dwordx4 v248, s[24:27], s73 offen offset:512 lds
  v_mfma_f32_16x16x32_bf16 v[212:215], a[144:147], v[208:211], v[212:215]
  v_exp_f32 v225, v41
  v_mfma_f32_16x16x32_bf16 v[212:215], a[184:187], v[192:195], v[212:215]
  v_exp_f32 v226, v42
  v_mfma_f32_16x16x32_bf16 v[212:215], a[224:227], a[100:103], v[212:215]
  v_exp_f32 v227, v43
  v_mfma_f32_16x16x32_bf16 v[212:215], a[28:31], a[156:159], v[212:215]
  v_exp_f32 v228, v132
  v_mfma_f32_16x16x32_bf16 v[20:23], a[248:251], a[92:95], 0
  v_exp_f32 v229, v133
  v_exp_f32 v230, v134
  v_exp_f32 v231, v135
  v_pk_mul_f32 v[124:125], v[124:125], v[232:233]
  v_pk_mul_f32 v[126:127], v[126:127], v[234:235]
  v_pk_mul_f32 v[112:113], v[112:113], v[236:237]
  v_pk_mul_f32 v[114:115], v[114:115], v[238:239]
  v_pk_mul_f32 v[156:157], v[156:157], s[48:49]
  v_pk_mul_f32 v[158:159], v[158:159], s[48:49]
  v_pk_mul_f32 v[0:1], v[0:1], s[48:49]
  v_pk_mul_f32 v[2:3], v[2:3], s[48:49]
  v_pk_fma_f32 v[224:225], v[224:225], s[50:51], s[50:51]
  v_pk_fma_f32 v[226:227], v[226:227], s[50:51], s[50:51]
  v_pk_fma_f32 v[228:229], v[228:229], s[50:51], s[50:51]
  v_pk_fma_f32 v[230:231], v[230:231], s[50:51], s[50:51]
  v_mfma_f32_16x16x32_bf16 v[20:23], a[188:191], a[244:247], v[20:23]
  buffer_store_dwordx2 v[182:183], v252, s[28:31], s86 offen sc1 nt
  v_mfma_f32_16x16x32_bf16 v[20:23], a[192:195], v[68:71], v[20:23]
  s_mov_b32 s86, 2097152
  v_cvt_pk_bf16_f32 v49, v184, v212
  v_cvt_pk_bf16_f32 v189, v185, v213
  v_mfma_f32_16x16x32_bf16 v[20:23], a[228:231], v[168:171], v[20:23]
  v_cvt_pk_bf16_f32 v51, v186, v214
  v_cvt_pk_bf16_f32 v191, v187, v215
  v_mfma_f32_16x16x32_bf16 v[20:23], a[232:235], v[104:107], v[20:23]
  v_rcp_f32 v224, v224
  v_mfma_f32_16x16x32_bf16 v[20:23], a[196:199], a[200:203], v[20:23]
  buffer_store_dwordx2 v[48:49], v252, s[28:31], s86 offen sc1 nt
  v_mfma_f32_16x16x32_bf16 v[20:23], a[16:19], a[8:11], v[20:23]
  s_mov_b32 s86, 2129920
  v_rcp_f32 v225, v225
  v_mfma_f32_16x16x32_bf16 v[20:23], a[20:23], a[208:211], v[20:23]
  v_cvt_pk_bf16_f32 v154, v124, v125
  v_cvt_pk_bf16_f32 v155, v126, v127
  v_mfma_f32_16x16x32_bf16 v[20:23], a[236:239], a[212:215], v[20:23]
  ds_write_b128 v222, v[152:155] offset:2048
  v_mfma_f32_16x16x32_bf16 v[20:23], a[64:67], a[32:35], v[20:23]
  buffer_store_dwordx2 v[188:189], v252, s[28:31], s86 offen sc1 nt
  v_cvt_pk_bf16_f32 v30, v112, v113
  v_mfma_f32_16x16x32_bf16 v[20:23], a[40:43], a[36:39], v[20:23]
  s_mov_b32 s86, 2162688
  ds_read_b64_tr_b16 v[52:53], v251 offset:32768
  ds_read_b64_tr_b16 v[54:55], v251 offset:34816
  v_mfma_f32_16x16x32_bf16 v[24:27], a[252:255], a[92:95], 0
  v_cvt_pk_bf16_f32 v31, v114, v115
  v_rcp_f32 v226, v226
  v_mfma_f32_16x16x32_bf16 v[24:27], a[188:191], v[12:15], v[24:27]
  ds_write_b128 v223, v[28:31] offset:3072
  v_mfma_f32_16x16x32_bf16 v[24:27], a[192:195], v[44:47], v[24:27]
  buffer_store_dwordx2 v[50:51], v252, s[28:31], s86 offen sc1 nt
  v_mfma_f32_16x16x32_bf16 v[24:27], a[228:231], a[4:7], v[24:27]
  s_mov_b32 s86, 2195456
  ds_read_b64_tr_b16 a[92:93], v251 offset:36864
  ds_read_b64_tr_b16 a[94:95], v251 offset:38912
  v_mfma_f32_16x16x32_bf16 v[24:27], a[232:235], a[48:51], v[24:27]
  v_rcp_f32 v227, v227
  v_mfma_f32_16x16x32_bf16 v[24:27], a[196:199], a[12:15], v[24:27]
  v_rcp_f32 v228, v228
  v_mfma_f32_16x16x32_bf16 v[24:27], a[16:19], a[56:59], v[24:27]
  buffer_store_dwordx2 v[190:191], v252, s[28:31], s86 offen sc1 nt
  v_mfma_f32_16x16x32_bf16 v[24:27], a[20:23], v[116:119], v[24:27]
  v_rcp_f32 v229, v229
  v_mfma_f32_16x16x32_bf16 v[24:27], a[236:239], v[164:167], v[24:27]
  v_rcp_f32 v230, v230
  v_mfma_f32_16x16x32_bf16 v[24:27], a[64:67], a[76:79], v[24:27]
  v_rcp_f32 v231, v231
  v_mfma_f32_16x16x32_bf16 v[24:27], a[40:43], a[80:83], v[24:27]
  v_exp_f32 v232, v156
  v_mfma_f32_16x16x32_bf16 v[56:59], a[248:251], a[96:99], 0
  v_exp_f32 v233, v157
  v_mfma_f32_16x16x32_bf16 v[56:59], a[188:191], v[60:63], v[56:59]
  v_exp_f32 v234, v158
  v_mfma_f32_16x16x32_bf16 v[56:59], a[192:195], v[92:95], v[56:59]
  v_exp_f32 v235, v159
  v_mfma_f32_16x16x32_bf16 v[56:59], a[228:231], a[52:55], v[56:59]
  v_cvt_pk_bf16_f32 v20, v20, v24
  v_cvt_pk_bf16_f32 v24, v21, v25
  v_mfma_f32_16x16x32_bf16 v[56:59], a[232:235], a[108:111], v[56:59]
  v_cvt_pk_bf16_f32 v22, v22, v26
  v_cvt_pk_bf16_f32 v26, v23, v27
  v_mfma_f32_16x16x32_bf16 v[56:59], a[196:199], a[60:63], v[56:59]
  v_exp_f32 v236, v0
  v_mfma_f32_16x16x32_bf16 v[56:59], a[16:19], a[120:123], v[56:59]
  v_exp_f32 v237, v1
  v_exp_f32 v238, v2
  v_exp_f32 v239, v3
  v_pk_mul_f32 v[40:41], v[40:41], v[224:225]
  v_pk_mul_f32 v[42:43], v[42:43], v[226:227]
  v_pk_mul_f32 v[132:133], v[132:133], v[228:229]
  v_pk_mul_f32 v[134:135], v[134:135], v[230:231]
  v_pk_mul_f32 v[72:73], v[72:73], s[48:49]
  v_pk_mul_f32 v[74:75], v[74:75], s[48:49]
  v_pk_mul_f32 v[148:149], v[148:149], s[48:49]
  v_pk_mul_f32 v[150:151], v[150:151], s[48:49]
  v_pk_fma_f32 v[232:233], v[232:233], s[50:51], s[50:51]
  v_pk_fma_f32 v[234:235], v[234:235], s[50:51], s[50:51]
  v_pk_fma_f32 v[236:237], v[236:237], s[50:51], s[50:51]
  v_pk_fma_f32 v[238:239], v[238:239], s[50:51], s[50:51]
  v_mfma_f32_16x16x32_bf16 v[56:59], a[20:23], v[204:207], v[56:59]
  v_rcp_f32 v232, v232
  v_mfma_f32_16x16x32_bf16 v[56:59], a[236:239], v[172:175], v[56:59]
  v_rcp_f32 v233, v233
  v_mfma_f32_16x16x32_bf16 v[56:59], a[64:67], a[148:151], v[56:59]
  v_cvt_pk_bf16_f32 v40, v40, v41
  v_cvt_pk_bf16_f32 v41, v42, v43
  v_mfma_f32_16x16x32_bf16 v[56:59], a[40:43], a[152:155], v[56:59]
  v_cvt_pk_bf16_f32 v132, v132, v133
  v_cvt_pk_bf16_f32 v133, v134, v135
  v_mfma_f32_16x16x32_bf16 v[84:87], a[252:255], a[96:99], 0
  v_rcp_f32 v234, v234
  v_mfma_f32_16x16x32_bf16 v[84:87], a[188:191], v[120:123], v[84:87]
  v_rcp_f32 v235, v235
  v_mfma_f32_16x16x32_bf16 v[84:87], a[192:195], v[136:139], v[84:87]
  v_rcp_f32 v236, v236
  v_mfma_f32_16x16x32_bf16 v[84:87], a[228:231], a[112:115], v[84:87]
  v_rcp_f32 v237, v237
  v_mfma_f32_16x16x32_bf16 v[84:87], a[232:235], a[160:163], v[84:87]
  v_rcp_f32 v238, v238
  v_mfma_f32_16x16x32_bf16 v[84:87], a[196:199], a[124:127], v[84:87]
  v_rcp_f32 v239, v239
  v_mfma_f32_16x16x32_bf16 v[84:87], a[16:19], a[168:171], v[84:87]
  v_exp_f32 v224, v72
  v_mfma_f32_16x16x32_bf16 v[84:87], a[20:23], v[208:211], v[84:87]
  v_exp_f32 v225, v73
  v_mfma_f32_16x16x32_bf16 v[84:87], a[236:239], v[192:195], v[84:87]
  v_exp_f32 v226, v74
  v_mfma_f32_16x16x32_bf16 v[84:87], a[64:67], a[100:103], v[84:87]
  v_exp_f32 v227, v75
  v_mfma_f32_16x16x32_bf16 v[84:87], a[40:43], a[156:159], v[84:87]
  s_mov_b32 s86, 4194304
  v_exp_f32 v228, v148
  v_mfma_f32_16x16x32_bf16 v[96:99], a[248:251], a[104:107], 0
  v_exp_f32 v229, v149
  v_exp_f32 v230, v150
  v_exp_f32 v231, v151
  v_pk_mul_f32 v[156:157], v[156:157], v[232:233]
  v_pk_mul_f32 v[158:159], v[158:159], v[234:235]
  v_pk_mul_f32 v[0:1], v[0:1], v[236:237]
  v_pk_mul_f32 v[2:3], v[2:3], v[238:239]
  v_pk_mul_f32 v[108:109], v[108:109], s[48:49]
  v_pk_mul_f32 v[110:111], v[110:111], s[48:49]
  v_pk_mul_f32 v[4:5], v[4:5], s[48:49]
  v_pk_mul_f32 v[6:7], v[6:7], s[48:49]
  v_pk_fma_f32 v[224:225], v[224:225], s[50:51], s[50:51]
  v_pk_fma_f32 v[226:227], v[226:227], s[50:51], s[50:51]
  v_pk_fma_f32 v[228:229], v[228:229], s[50:51], s[50:51]
  v_pk_fma_f32 v[230:231], v[230:231], s[50:51], s[50:51]
  v_mfma_f32_16x16x32_bf16 v[96:99], a[44:47], a[244:247], v[96:99]
  v_cvt_pk_bf16_f32 v21, v56, v84
  v_cvt_pk_bf16_f32 v25, v57, v85
  v_mfma_f32_16x16x32_bf16 v[96:99], v[176:179], v[68:71], v[96:99]
  buffer_store_dwordx2 v[20:21], v252, s[28:31], s86 offen sc1 nt
  v_mfma_f32_16x16x32_bf16 v[96:99], v[32:35], v[168:171], v[96:99]
  s_mov_b32 s86, 4227072
  v_cvt_pk_bf16_f32 v23, v58, v86
  v_cvt_pk_bf16_f32 v27, v59, v87
  v_mfma_f32_16x16x32_bf16 v[96:99], v[240:243], v[104:107], v[96:99]
  v_rcp_f32 v224, v224
  v_mfma_f32_16x16x32_bf16 v[96:99], v[196:199], a[200:203], v[96:99]
  s_waitcnt vmcnt(13) lgkmcnt(0)
  s_barrier
  v_mfma_f32_16x16x32_bf16 v[96:99], a[84:87], a[8:11], v[96:99]
  buffer_store_dwordx2 v[24:25], v252, s[28:31], s86 offen sc1 nt
  v_mfma_f32_16x16x32_bf16 v[96:99], v[216:219], a[208:211], v[96:99]
  s_mov_b32 s86, 4259840
  ds_read_b64_tr_b16 a[96:97], v251 offset:61440
  ds_read_b64_tr_b16 a[98:99], v251 offset:63488
  v_mfma_f32_16x16x32_bf16 v[96:99], v[200:203], a[212:215], v[96:99]
  v_rcp_f32 v225, v225
  v_mfma_f32_16x16x32_bf16 v[96:99], v[80:83], a[32:35], v[96:99]
  ds_read_b64_tr_b16 v[140:141], v250 offset:49152
  ds_read_b64_tr_b16 v[142:143], v250 offset:51200
  v_mfma_f32_16x16x32_bf16 v[96:99], v[8:11], a[36:39], v[96:99]
  buffer_store_dwordx2 v[22:23], v252, s[28:31], s86 offen sc1 nt
  v_mfma_f32_16x16x32_bf16 v[76:79], a[252:255], a[104:107], 0
  s_mov_b32 s86, 4292608
  ds_read_b64_tr_b16 a[104:105], v250 offset:53248
  ds_read_b64_tr_b16 a[106:107], v250 offset:55296
  v_mfma_f32_16x16x32_bf16 v[76:79], a[44:47], v[12:15], v[76:79]
  v_cvt_pk_bf16_f32 v156, v156, v157
  v_cvt_pk_bf16_f32 v157, v158, v159
  v_mfma_f32_16x16x32_bf16 v[76:79], v[176:179], v[44:47], v[76:79]
  v_cvt_pk_bf16_f32 v0, v0, v1
  v_cvt_pk_bf16_f32 v1, v2, v3
  v_mfma_f32_16x16x32_bf16 v[76:79], v[32:35], a[4:7], v[76:79]
  buffer_store_dwordx2 v[26:27], v252, s[28:31], s86 offen sc1 nt
  v_mfma_f32_16x16x32_bf16 v[76:79], v[240:243], a[48:51], v[76:79]
  v_rcp_f32 v226, v226
  v_mfma_f32_16x16x32_bf16 v[76:79], v[196:199], a[12:15], v[76:79]
  v_rcp_f32 v227, v227
  v_mfma_f32_16x16x32_bf16 v[76:79], a[84:87], a[56:59], v[76:79]
  v_rcp_f32 v228, v228
  v_mfma_f32_16x16x32_bf16 v[76:79], v[216:219], v[116:119], v[76:79]
  v_rcp_f32 v229, v229
  v_mfma_f32_16x16x32_bf16 v[76:79], v[200:203], v[164:167], v[76:79]
  v_rcp_f32 v230, v230
  v_mfma_f32_16x16x32_bf16 v[76:79], v[80:83], a[76:79], v[76:79]
  v_rcp_f32 v231, v231
  v_mfma_f32_16x16x32_bf16 v[76:79], v[8:11], a[80:83], v[76:79]
  v_exp_f32 v232, v108
  v_mfma_f32_16x16x32_bf16 v[88:91], a[248:251], a[116:119], 0
  v_exp_f32 v233, v109
  v_mfma_f32_16x16x32_bf16 v[88:91], a[44:47], v[60:63], v[88:91]
  v_exp_f32 v234, v110
  v_mfma_f32_16x16x32_bf16 v[88:91], v[176:179], v[92:95], v[88:91]
  v_exp_f32 v235, v111
  v_mfma_f32_16x16x32_bf16 v[88:91], v[32:35], a[52:55], v[88:91]
  v_cvt_pk_bf16_f32 v96, v96, v76
  v_cvt_pk_bf16_f32 v76, v97, v77
  v_mfma_f32_16x16x32_bf16 v[88:91], v[240:243], a[108:111], v[88:91]
  v_cvt_pk_bf16_f32 v98, v98, v78
  v_cvt_pk_bf16_f32 v78, v99, v79
  v_mfma_f32_16x16x32_bf16 v[88:91], v[196:199], a[60:63], v[88:91]
  v_exp_f32 v236, v4
  v_mfma_f32_16x16x32_bf16 v[88:91], a[84:87], a[120:123], v[88:91]
  v_exp_f32 v237, v5
  v_exp_f32 v238, v6
  v_exp_f32 v239, v7
  v_pk_mul_f32 v[72:73], v[72:73], v[224:225]
  v_pk_mul_f32 v[74:75], v[74:75], v[226:227]
  v_pk_mul_f32 v[148:149], v[148:149], v[228:229]
  v_pk_mul_f32 v[150:151], v[150:151], v[230:231]
  v_pk_mul_f32 v[16:17], v[16:17], s[48:49]
  v_pk_mul_f32 v[18:19], v[18:19], s[48:49]
  v_pk_mul_f32 v[100:101], v[100:101], s[48:49]
  v_pk_mul_f32 v[102:103], v[102:103], s[48:49]
  v_pk_fma_f32 v[232:233], v[232:233], s[50:51], s[50:51]
  v_pk_fma_f32 v[234:235], v[234:235], s[50:51], s[50:51]
  v_pk_fma_f32 v[236:237], v[236:237], s[50:51], s[50:51]
  v_pk_fma_f32 v[238:239], v[238:239], s[50:51], s[50:51]
  v_mfma_f32_16x16x32_bf16 v[88:91], v[216:219], v[204:207], v[88:91]
  v_rcp_f32 v232, v232
  v_mfma_f32_16x16x32_bf16 v[88:91], v[200:203], v[172:175], v[88:91]
  v_rcp_f32 v233, v233
  v_mfma_f32_16x16x32_bf16 v[88:91], v[80:83], a[148:151], v[88:91]
  v_cvt_pk_bf16_f32 v42, v72, v73
  v_cvt_pk_bf16_f32 v43, v74, v75
  v_mfma_f32_16x16x32_bf16 v[88:91], v[8:11], a[152:155], v[88:91]
  v_cvt_pk_bf16_f32 v134, v148, v149
  v_cvt_pk_bf16_f32 v135, v150, v151
  v_mfma_f32_16x16x32_bf16 v[180:183], a[252:255], a[116:119], 0
  s_waitcnt vmcnt(9) lgkmcnt(0)
  s_barrier
  v_mfma_f32_16x16x32_bf16 v[180:183], a[44:47], v[120:123], v[180:183]
  ds_write_b128 v220, v[40:43] offset:16384
  v_mfma_f32_16x16x32_bf16 v[180:183], v[176:179], v[136:139], v[180:183]
  ds_write_b128 v221, v[132:135] offset:17408
  v_mfma_f32_16x16x32_bf16 v[180:183], v[32:35], a[112:115], v[180:183]
  v_rcp_f32 v234, v234
  v_mfma_f32_16x16x32_bf16 v[180:183], v[240:243], a[160:163], v[180:183]
  ds_read_b64_tr_b16 a[116:117], v250 offset:57344
  v_rcp_f32 v235, v235
  v_mfma_f32_16x16x32_bf16 v[180:183], v[196:199], a[124:127], v[180:183]
  ds_read_b64_tr_b16 a[118:119], v250 offset:59392
  ds_read_b64_tr_b16 v[160:161], v250 offset:61440
  v_mfma_f32_16x16x32_bf16 v[180:183], a[84:87], a[168:171], v[180:183]
  v_rcp_f32 v236, v236
  v_mfma_f32_16x16x32_bf16 v[180:183], v[216:219], v[208:211], v[180:183]
  ds_read_b64_tr_b16 v[162:163], v250 offset:63488
  ds_read_b64_tr_b16 v[124:125], v251 offset:4096
  v_mfma_f32_16x16x32_bf16 v[180:183], v[200:203], v[192:195], v[180:183]
  v_rcp_f32 v237, v237
  v_mfma_f32_16x16x32_bf16 v[180:183], v[80:83], a[100:103], v[180:183]
  ds_read_b64_tr_b16 v[126:127], v251 offset:6144
  ds_read_b64_tr_b16 v[152:153], v251 offset:8192
  v_mfma_f32_16x16x32_bf16 v[180:183], v[8:11], a[156:159], v[180:183]
  s_mov_b32 s86, 6291456
  v_rcp_f32 v238, v238
  v_mfma_f32_16x16x32_bf16 v[112:115], a[248:251], a[132:135], 0
  ds_read_b64_tr_b16 v[154:155], v251 offset:10240
  v_subrev_u32 v244, 40960, v244
  v_subrev_u32 v245, 40960, v245
  v_subrev_u32 v246, 40960, v246
  v_subrev_u32 v247, 40960, v247
  v_mfma_f32_16x16x32_bf16 v[112:115], a[88:91], a[244:247], v[112:115]
  ds_read_b128 a[244:247], v244
  ds_read_b128 v[184:187], v244 offset:4096
  v_mfma_f32_16x16x32_bf16 v[112:115], v[52:55], v[68:71], v[112:115]
  v_cvt_pk_bf16_f32 v97, v88, v180
  v_cvt_pk_bf16_f32 v77, v89, v181
  v_mfma_f32_16x16x32_bf16 v[112:115], a[92:95], v[168:171], v[112:115]
  buffer_store_dwordx2 v[96:97], v252, s[28:31], s86 offen sc1 nt
  v_mfma_f32_16x16x32_bf16 v[112:115], a[96:99], v[104:107], v[112:115]
  s_mov_b32 s86, 6324224
  ds_read_b128 v[212:215], v245
  ds_read_b128 v[20:23], v245 offset:4096
  v_mfma_f32_16x16x32_bf16 v[112:115], v[140:143], a[200:203], v[112:115]
  v_cvt_pk_bf16_f32 v99, v90, v182
  v_cvt_pk_bf16_f32 v79, v91, v183
  v_mfma_f32_16x16x32_bf16 v[112:115], a[104:107], a[8:11], v[112:115]
  s_waitcnt lgkmcnt(8)
  ds_read_b128 a[200:203], v246
  ds_read_b128 a[8:11], v246 offset:4096
  v_mfma_f32_16x16x32_bf16 v[112:115], a[116:119], a[208:211], v[112:115]
  buffer_store_dwordx2 v[76:77], v252, s[28:31], s86 offen sc1 nt
  v_mfma_f32_16x16x32_bf16 v[112:115], v[160:163], a[212:215], v[112:115]
  s_waitcnt lgkmcnt(6)
  ds_read_b128 a[208:211], v247
  ds_read_b128 a[212:215], v247 offset:4096
  v_mfma_f32_16x16x32_bf16 v[112:115], v[124:127], a[32:35], v[112:115]
  s_mov_b32 s86, 6356992
  v_rcp_f32 v239, v239
  v_mfma_f32_16x16x32_bf16 v[112:115], v[152:155], a[36:39], v[112:115]
  ds_read_b128 a[32:35], v244 offset:8192
  v_exp_f32 v224, v16
  v_mfma_f32_16x16x32_bf16 v[28:31], a[252:255], a[132:135], 0
  buffer_store_dwordx2 v[98:99], v252, s[28:31], s86 offen sc1 nt
  v_mfma_f32_16x16x32_bf16 v[28:31], a[88:91], v[12:15], v[28:31]
  s_mov_b32 s86, 6389760
  ds_read_b128 a[36:39], v244 offset:12288
  ds_read_b128 a[132:135], v245 offset:8192
  v_mfma_f32_16x16x32_bf16 v[28:31], v[52:55], v[44:47], v[28:31]
L_pg4:
  s_cbranch_execz L_ret
  v_exp_f32 v225, v17
  v_mfma_f32_16x16x32_bf16 v[28:31], a[92:95], a[4:7], v[28:31]
  ds_read_b128 a[4:7], v245 offset:12288
  ds_read_b128 v[24:27], v246 offset:8192
  v_mfma_f32_16x16x32_bf16 v[28:31], a[96:99], a[48:51], v[28:31]
  buffer_store_dwordx2 v[78:79], v252, s[28:31], s86 offen sc1 nt
  v_mfma_f32_16x16x32_bf16 v[28:31], v[140:143], a[12:15], v[28:31]
  ds_read_b128 a[48:51], v246 offset:12288
  v_exp_f32 v226, v18
  v_mfma_f32_16x16x32_bf16 v[28:31], a[104:107], a[56:59], v[28:31]
  ds_read_b128 a[12:15], v247 offset:8192
  v_exp_f32 v227, v19
  v_mfma_f32_16x16x32_bf16 v[28:31], a[116:119], v[116:119], v[28:31]
  ds_read_b128 a[56:59], v247 offset:12288
  v_exp_f32 v228, v100
  v_mfma_f32_16x16x32_bf16 v[28:31], v[160:163], v[164:167], v[28:31]
  v_exp_f32 v229, v101
  v_exp_f32 v230, v102
  v_exp_f32 v231, v103
  v_pk_mul_f32 v[108:109], v[108:109], v[232:233]
  v_pk_mul_f32 v[110:111], v[110:111], v[234:235]
  v_pk_mul_f32 v[4:5], v[4:5], v[236:237]
  v_pk_mul_f32 v[6:7], v[6:7], v[238:239]
  v_pk_mul_f32 v[144:145], v[144:145], s[48:49]
  v_pk_mul_f32 v[146:147], v[146:147], s[48:49]
  v_pk_mul_f32 v[64:65], v[64:65], s[48:49]
  v_pk_mul_f32 v[66:67], v[66:67], s[48:49]
  v_pk_fma_f32 v[224:225], v[224:225], s[50:51], s[50:51]
  v_pk_fma_f32 v[226:227], v[226:227], s[50:51], s[50:51]
  v_pk_fma_f32 v[228:229], v[228:229], s[50:51], s[50:51]
  v_pk_fma_f32 v[230:231], v[230:231], s[50:51], s[50:51]
  v_mfma_f32_16x16x32_bf16 v[28:31], v[124:127], a[76:79], v[28:31]
  v_rcp_f32 v224, v224
  v_mfma_f32_16x16x32_bf16 v[28:31], v[152:155], a[80:83], v[28:31]
  v_rcp_f32 v225, v225
  v_mfma_f32_16x16x32_bf16 v[48:51], a[248:251], a[136:139], 0
  v_cvt_pk_bf16_f32 v158, v108, v109
  v_cvt_pk_bf16_f32 v159, v110, v111
  v_mfma_f32_16x16x32_bf16 v[48:51], a[88:91], v[60:63], v[48:51]
  ds_write_b128 v222, v[156:159] offset:18432
  v_mfma_f32_16x16x32_bf16 v[48:51], v[52:55], v[92:95], v[48:51]
  v_cvt_pk_bf16_f32 v2, v4, v5
  v_cvt_pk_bf16_f32 v112, v112, v28
  v_mfma_f32_16x16x32_bf16 v[48:51], a[92:95], a[52:55], v[48:51]
  v_cvt_pk_bf16_f32 v28, v113, v29
  v_cvt_pk_bf16_f32 v114, v114, v30
  v_mfma_f32_16x16x32_bf16 v[48:51], a[96:99], a[108:111], v[48:51]
  v_cvt_pk_bf16_f32 v30, v115, v31
  v_cvt_pk_bf16_f32 v3, v6, v7
  v_mfma_f32_16x16x32_bf16 v[48:51], v[140:143], a[60:63], v[48:51]
  ds_write_b128 v223, v[0:3] offset:19456
  v_mfma_f32_16x16x32_bf16 v[48:51], a[104:107], a[120:123], v[48:51]
  v_add_u32 v254, s87, v254
  v_add_u32 v255, s87, v255
  v_mfma_f32_16x16x32_bf16 v[48:51], a[116:119], v[204:207], v[48:51]
  ds_read2_b32 a[76:77], v254 offset0:0 offset1:32
  v_rcp_f32 v226, v226
  v_mfma_f32_16x16x32_bf16 v[48:51], v[160:163], v[172:175], v[48:51]
  ds_read2_b32 a[78:79], v255 offset0:0 offset1:32
  v_rcp_f32 v227, v227
  v_mfma_f32_16x16x32_bf16 v[48:51], v[124:127], a[148:151], v[48:51]
  v_rcp_f32 v228, v228
  v_mfma_f32_16x16x32_bf16 v[48:51], v[152:155], a[152:155], v[48:51]
  v_rcp_f32 v229, v229
  v_mfma_f32_16x16x32_bf16 v[188:191], a[252:255], a[136:139], 0
  ds_read2_b32 a[80:81], v254 offset0:1 offset1:33
  v_rcp_f32 v230, v230
  v_mfma_f32_16x16x32_bf16 v[188:191], a[88:91], v[120:123], v[188:191]
  v_rcp_f32 v231, v231
  v_mfma_f32_16x16x32_bf16 v[188:191], v[52:55], v[136:139], v[188:191]
  ds_read2_b32 a[82:83], v255 offset0:1 offset1:33
  v_exp_f32 v232, v144
  v_mfma_f32_16x16x32_bf16 v[188:191], a[92:95], a[112:115], v[188:191]
  v_exp_f32 v233, v145
  v_mfma_f32_16x16x32_bf16 v[188:191], a[96:99], a[160:163], v[188:191]
  v_exp_f32 v234, v146
  v_mfma_f32_16x16x32_bf16 v[188:191], v[140:143], a[124:127], v[188:191]
  v_exp_f32 v235, v147
  v_mfma_f32_16x16x32_bf16 v[188:191], a[104:107], a[168:171], v[188:191]
  v_exp_f32 v236, v64
  v_mfma_f32_16x16x32_bf16 v[188:191], a[116:119], v[208:211], v[188:191]
  v_exp_f32 v237, v65
  v_mfma_f32_16x16x32_bf16 v[188:191], v[160:163], v[192:195], v[188:191]
  v_exp_f32 v238, v66
  v_mfma_f32_16x16x32_bf16 v[188:191], v[124:127], a[100:103], v[188:191]
  v_exp_f32 v239, v67
  v_mfma_f32_16x16x32_bf16 v[188:191], v[152:155], a[156:159], v[188:191]
  s_waitcnt lgkmcnt(2)
  s_mov_b32 s86, 8388608
  s_barrier
  v_mfma_f32_16x16x32_bf16 v[56:59], a[248:251], a[76:79], 0
  ds_read_b128 a[52:55], v244 offset:16384
  ds_read_b128 a[108:111], v244 offset:20480
  v_mfma_f32_16x16x32_bf16 v[56:59], a[240:243], a[244:247], v[56:59]
  v_mul_f32 v16, v224, v16
  v_cvt_pk_bf16_f32 v113, v48, v188
  v_mfma_f32_16x16x32_bf16 v[56:59], v[36:39], v[184:187], v[56:59]
  buffer_store_dwordx2 v[112:113], v252, s[28:31], s86 offen sc1 nt
  v_mfma_f32_16x16x32_bf16 v[84:87], a[252:255], a[76:79], 0
  s_mov_b32 s86, 8421376
  ds_read_b128 a[60:63], v245 offset:16384
  ds_read_b128 a[120:123], v245 offset:20480
  v_mfma_f32_16x16x32_bf16 v[84:87], a[240:243], v[212:215], v[84:87]
  v_cvt_pk_bf16_f32 v29, v49, v189
  v_cvt_pk_bf16_f32 v115, v50, v190
  v_mfma_f32_16x16x32_bf16 v[84:87], v[36:39], v[20:23], v[84:87]
  s_waitcnt lgkmcnt(4)
  ds_read_b128 a[148:151], v246 offset:16384
  ds_read_b128 a[152:155], v246 offset:20480
  v_mfma_f32_16x16x32_bf16 v[72:75], a[248:251], a[80:83], 0
  buffer_store_dwordx2 v[28:29], v252, s[28:31], s86 offen sc1 nt
  v_cvt_pk_bf16_f32 v31, v51, v191
  v_mfma_f32_16x16x32_bf16 v[72:75], a[240:243], a[200:203], v[72:75]
  s_mov_b32 s86, 8454144
  ds_read_b128 a[136:139], v247 offset:16384
  ds_read_b128 a[112:115], v247 offset:20480
  v_mfma_f32_16x16x32_bf16 v[72:75], v[36:39], a[8:11], v[72:75]
  v_mul_f32 v17, v225, v17
  v_mul_f32 v18, v226, v18
  v_mfma_f32_16x16x32_bf16 v[148:151], a[252:255], a[80:83], 0
  ds_read_b128 a[160:163], v244 offset:24576
  v_mul_f32 v19, v227, v19
  v_mfma_f32_16x16x32_bf16 v[148:151], a[240:243], a[208:211], v[148:151]
  buffer_store_dwordx2 v[114:115], v252, s[28:31], s86 offen sc1 nt
  v_mfma_f32_16x16x32_bf16 v[148:151], v[36:39], a[212:215], v[148:151]
  s_mov_b32 s86, 8486912
  ds_read_b128 a[124:127], v244 offset:28672
  ds_read_b128 a[168:171], v245 offset:24576
  v_mfma_f32_16x16x32_bf16 v[56:59], v[128:131], a[32:35], v[56:59]
  v_add_u32 v254, s32, v254
  v_add_u32 v255, s32, v255
  v_mfma_f32_16x16x32_bf16 v[56:59], a[0:3], a[36:39], v[56:59]
  ds_read2_b32 a[100:101], v254 offset0:0 offset1:32
  v_mul_f32 v100, v228, v100
  v_mfma_f32_16x16x32_bf16 v[84:87], v[128:131], a[132:135], v[84:87]
  buffer_store_dwordx2 v[30:31], v252, s[28:31], s86 offen sc1 nt
  v_mfma_f32_16x16x32_bf16 v[84:87], a[0:3], a[4:7], v[84:87]
  ds_read2_b32 a[102:103], v255 offset0:0 offset1:32
  v_mul_f32 v101, v229, v101
  v_mfma_f32_16x16x32_bf16 v[72:75], v[128:131], v[24:27], v[72:75]
  v_mul_f32 v102, v230, v102
  v_mul_f32 v103, v231, v103
  v_mfma_f32_16x16x32_bf16 v[72:75], a[0:3], a[48:51], v[72:75]
  v_add_u32 v220, s53, v220
  v_add_u32 v221, s53, v221
  v_add_u32 v222, s53, v222
  v_add_u32 v223, s53, v223
  v_cvt_pk_bf16_f32 v16, v16, v17
  v_cvt_pk_bf16_f32 v17, v18, v19
  v_mfma_f32_16x16x32_bf16 v[148:151], v[128:131], a[12:15], v[148:151]
  ds_write_b64 v220, v[16:17] offset:32768
  v_mfma_f32_16x16x32_bf16 v[148:151], a[0:3], a[56:59], v[148:151]
  s_waitcnt lgkmcnt(5)
  ds_read2_b32 a[156:157], v254 offset0:1 offset1:33
  v_cvt_pk_bf16_f32 v100, v100, v101
  v_mfma_f32_16x16x32_bf16 v[56:59], a[164:167], a[52:55], v[56:59]
  v_cvt_pk_bf16_f32 v101, v102, v103
  v_fma_f32 v232, v232, s50, s50
  v_mfma_f32_16x16x32_bf16 v[56:59], a[204:207], a[108:111], v[56:59]
  ds_write_b64 v221, v[100:101] offset:33792
  v_mfma_f32_16x16x32_bf16 v[84:87], a[164:167], a[60:63], v[84:87]
  v_fma_f32 v233, v233, s50, s50
  v_fma_f32 v234, v234, s50, s50
  v_mfma_f32_16x16x32_bf16 v[84:87], a[204:207], a[120:123], v[84:87]
  ds_read2_b32 a[158:159], v255 offset0:1 offset1:33
  v_fma_f32 v235, v235, s50, s50
  v_mfma_f32_16x16x32_bf16 v[72:75], a[164:167], a[148:151], v[72:75]
  v_fma_f32 v236, v236, s50, s50
  v_fma_f32 v237, v237, s50, s50
  v_mfma_f32_16x16x32_bf16 v[72:75], a[204:207], a[152:155], v[72:75]
  v_fma_f32 v238, v238, s50, s50
  v_fma_f32 v239, v239, s50, s50
  v_mfma_f32_16x16x32_bf16 v[148:151], a[164:167], a[136:139], v[148:151]
  ds_read_b128 a[76:79], v245 offset:28672
  v_rcp_f32 v232, v232
  v_mfma_f32_16x16x32_bf16 v[148:151], a[204:207], a[112:115], v[148:151]
  s_waitcnt lgkmcnt(5)
  ds_read_b128 a[80:83], v246 offset:24576
  v_rcp_f32 v233, v233
  v_mfma_f32_16x16x32_bf16 v[40:43], a[248:251], a[100:103], 0
  ds_read_b128 a[240:243], v246 offset:28672
  v_rcp_f32 v234, v234
  v_mfma_f32_16x16x32_bf16 v[40:43], a[176:179], a[244:247], v[40:43]
  ds_read_b128 a[0:3], v247 offset:24576
  v_rcp_f32 v235, v235
  v_mfma_f32_16x16x32_bf16 v[40:43], a[180:183], v[184:187], v[40:43]
  ds_read_b128 a[164:167], v247 offset:28672
  v_rcp_f32 v236, v236
  v_mfma_f32_16x16x32_bf16 v[132:135], a[252:255], a[100:103], 0
  v_rcp_f32 v237, v237
  v_mfma_f32_16x16x32_bf16 v[132:135], a[176:179], v[212:215], v[132:135]
  v_rcp_f32 v238, v238
  v_mfma_f32_16x16x32_bf16 v[132:135], a[180:183], v[20:23], v[132:135]
  v_rcp_f32 v239, v239
  s_waitcnt lgkmcnt(5)
  v_mul_f32 v144, v232, v144
  v_mul_f32 v145, v233, v145
  v_mul_f32 v146, v234, v146
  v_mul_f32 v147, v235, v147
  v_mul_f32 v64, v236, v64
  v_mul_f32 v65, v237, v65
  v_mul_f32 v66, v238, v66
  v_mul_f32 v67, v239, v67
  v_cvt_pk_bf16_f32 v144, v144, v145
  v_cvt_pk_bf16_f32 v145, v146, v147
  v_cvt_pk_bf16_f32 v64, v64, v65
  v_cvt_pk_bf16_f32 v65, v66, v67
  v_mfma_f32_16x16x32_bf16 v[68:71], a[248:251], a[156:159], 0
  ds_write_b64 v222, v[144:145] offset:34816
  v_mfma_f32_16x16x32_bf16 v[68:71], a[176:179], a[200:203], v[68:71]
  ds_write_b64 v223, v[64:65] offset:35840
  v_mfma_f32_16x16x32_bf16 v[68:71], a[180:183], a[8:11], v[68:71]
  v_mfma_f32_16x16x32_bf16 v[168:171], a[252:255], a[156:159], 0
  v_mfma_f32_16x16x32_bf16 v[168:171], a[176:179], a[208:211], v[168:171]
  v_mfma_f32_16x16x32_bf16 v[168:171], a[180:183], a[212:215], v[168:171]
  v_add_u32 v254, s33, v254
  v_add_u32 v255, s33, v255
  v_mfma_f32_16x16x32_bf16 v[40:43], a[216:219], a[32:35], v[40:43]
  ds_read2_b32 v[104:105], v254 offset0:0 offset1:32
  ds_read2_b32 v[106:107], v255 offset0:0 offset1:32
  v_mfma_f32_16x16x32_bf16 v[40:43], a[220:223], a[36:39], v[40:43]
  v_mfma_f32_16x16x32_bf16 v[132:135], a[216:219], a[132:135], v[132:135]
  v_mfma_f32_16x16x32_bf16 v[132:135], a[220:223], a[4:7], v[132:135]
  ds_read2_b32 v[12:13], v254 offset0:1 offset1:33
  v_mfma_f32_16x16x32_bf16 v[68:71], a[216:219], v[24:27], v[68:71]
  v_mfma_f32_16x16x32_bf16 v[68:71], a[220:223], a[48:51], v[68:71]
  v_mfma_f32_16x16x32_bf16 v[168:171], a[216:219], a[12:15], v[168:171]
  s_waitcnt lgkmcnt(3)
  s_barrier
  v_mfma_f32_16x16x32_bf16 v[168:171], a[220:223], a[56:59], v[168:171]
  ds_read2_b32 v[14:15], v255 offset0:1 offset1:33
  ds_read_b128 a[204:207], v244 offset:32768
  v_mfma_f32_16x16x32_bf16 v[40:43], a[24:27], a[52:55], v[40:43]
  v_mfma_f32_16x16x32_bf16 v[40:43], a[72:75], a[108:111], v[40:43]
  ds_read_b128 a[100:103], v244 offset:36864
  v_mfma_f32_16x16x32_bf16 v[132:135], a[24:27], a[60:63], v[132:135]
  ds_read_b128 a[156:159], v245 offset:32768
  v_mfma_f32_16x16x32_bf16 v[132:135], a[72:75], a[120:123], v[132:135]
  v_mfma_f32_16x16x32_bf16 v[68:71], a[24:27], a[148:151], v[68:71]
  ds_read_b128 a[176:179], v245 offset:36864
  v_mfma_f32_16x16x32_bf16 v[68:71], a[72:75], a[152:155], v[68:71]
  ds_read_b128 a[180:183], v246 offset:32768
  v_mfma_f32_16x16x32_bf16 v[168:171], a[24:27], a[136:139], v[168:171]
  v_mfma_f32_16x16x32_bf16 v[168:171], a[72:75], a[112:115], v[168:171]
  ds_read_b128 a[216:219], v246 offset:36864
  v_mfma_f32_16x16x32_bf16 v[56:59], a[172:175], a[160:163], v[56:59]
  ds_read_b128 a[220:223], v247 offset:32768
  v_mfma_f32_16x16x32_bf16 v[56:59], a[68:71], a[124:127], v[56:59]
  ds_read_b128 a[24:27], v247 offset:36864
  s_waitcnt lgkmcnt(9)
  v_lshlrev_b32 v44, 16, v104
  v_mfma_f32_16x16x32_bf16 v[84:87], a[172:175], a[168:171], v[84:87]
  v_and_b32 v96, s47, v104
  v_lshlrev_b32 v45, 16, v105
  v_mfma_f32_16x16x32_bf16 v[84:87], a[68:71], a[76:79], v[84:87]
  v_and_b32 v97, s47, v105
  v_lshlrev_b32 v46, 16, v106
  v_mfma_f32_16x16x32_bf16 v[72:75], a[172:175], a[80:83], v[72:75]
  v_and_b32 v98, s47, v106
  v_lshlrev_b32 v47, 16, v107
  v_mfma_f32_16x16x32_bf16 v[72:75], a[68:71], a[240:243], v[72:75]
  v_and_b32 v99, s47, v107
  v_lshlrev_b32 v76, 16, v12
  v_mfma_f32_16x16x32_bf16 v[148:151], a[172:175], a[0:3], v[148:151]
  v_and_b32 v88, s47, v12
  v_lshlrev_b32 v77, 16, v13
  v_mfma_f32_16x16x32_bf16 v[148:151], a[68:71], a[164:167], v[148:151]
  s_waitcnt lgkmcnt(5)
  v_and_b32 v89, s47, v13
  v_lshlrev_b32 v78, 16, v14
  v_mfma_f32_16x16x32_bf16 v[56:59], a[128:131], a[204:207], v[56:59]
  v_and_b32 v90, s47, v14
  v_lshlrev_b32 v79, 16, v15
  v_mfma_f32_16x16x32_bf16 v[56:59], a[140:143], a[100:103], v[56:59]
  v_and_b32 v91, s47, v15
  v_mul_f32 v44, s52, v44
  v_mfma_f32_16x16x32_bf16 v[84:87], a[128:131], a[156:159], v[84:87]
  s_waitcnt lgkmcnt(3)
  v_mul_f32 v45, s52, v45
  v_mul_f32 v46, s52, v46
  v_mfma_f32_16x16x32_bf16 v[84:87], a[140:143], a[176:179], v[84:87]
  v_mul_f32 v47, s52, v47
  v_mul_f32 v96, s52, v96
  v_mfma_f32_16x16x32_bf16 v[72:75], a[128:131], a[180:183], v[72:75]
  s_waitcnt lgkmcnt(2)
  v_mul_f32 v97, s52, v97
  v_mul_f32 v98, s52, v98
  v_mfma_f32_16x16x32_bf16 v[72:75], a[140:143], a[216:219], v[72:75]
  s_waitcnt lgkmcnt(1)
  v_cvt_pk_bf16_f32 v56, v56, v84
  v_cvt_pk_bf16_f32 v84, v57, v85
  v_mfma_f32_16x16x32_bf16 v[148:151], a[128:131], a[220:223], v[148:151]
  s_waitcnt lgkmcnt(0)
  v_cvt_pk_bf16_f32 v58, v58, v86
  v_cvt_pk_bf16_f32 v86, v59, v87
  v_mfma_f32_16x16x32_bf16 v[148:151], a[140:143], a[24:27], v[148:151]
  s_mov_b32 s86, 0
  v_mul_f32 v99, s52, v99
  v_mul_f32 v76, s52, v76
  v_mfma_f32_16x16x32_bf16 v[40:43], a[144:147], a[160:163], v[40:43]
  v_mul_f32 v77, s52, v77
  v_mul_f32 v78, s52, v78
  v_mfma_f32_16x16x32_bf16 v[40:43], a[184:187], a[124:127], v[40:43]
  v_mul_f32 v79, s52, v79
  v_cvt_pk_bf16_f32 v57, v72, v148
  v_mfma_f32_16x16x32_bf16 v[132:135], a[144:147], a[168:171], v[132:135]
  buffer_store_dwordx2 v[56:57], v252, s[28:31], s86 offen offset:128 sc1 nt
  v_mfma_f32_16x16x32_bf16 v[132:135], a[184:187], a[76:79], v[132:135]
  s_mov_b32 s86, 32768
  v_mfma_f32_16x16x32_bf16 v[68:71], a[144:147], a[80:83], v[68:71]
  v_cvt_pk_bf16_f32 v85, v73, v149
  v_cvt_pk_bf16_f32 v59, v74, v150
  v_mfma_f32_16x16x32_bf16 v[68:71], a[184:187], a[240:243], v[68:71]
  v_cvt_pk_bf16_f32 v87, v75, v151
  v_mfma_f32_16x16x32_bf16 v[168:171], a[144:147], a[0:3], v[168:171]
  buffer_store_dwordx2 v[84:85], v252, s[28:31], s86 offen offset:128 sc1 nt
  v_mfma_f32_16x16x32_bf16 v[168:171], a[184:187], a[164:167], v[168:171]
  s_mov_b32 s86, 65536
  v_mul_f32 v88, s52, v88
  v_mul_f32 v89, s52, v89
  v_mfma_f32_16x16x32_bf16 v[40:43], a[224:227], a[204:207], v[40:43]
  v_add_u32 v254, s34, v254
  v_add_u32 v255, s34, v255
  v_mfma_f32_16x16x32_bf16 v[40:43], a[28:31], a[100:103], v[40:43]
  ds_read2_b32 v[180:181], v254 offset0:0 offset1:32
  v_mfma_f32_16x16x32_bf16 v[132:135], a[224:227], a[156:159], v[132:135]
  buffer_store_dwordx2 v[58:59], v252, s[28:31], s86 offen offset:128 sc1 nt
  v_mfma_f32_16x16x32_bf16 v[132:135], a[28:31], a[176:179], v[132:135]
  s_mov_b32 s86, 98304
  ds_read2_b32 v[182:183], v255 offset0:0 offset1:32
  v_mfma_f32_16x16x32_bf16 v[68:71], a[224:227], a[180:183], v[68:71]
  ds_read2_b32 v[116:117], v254 offset0:1 offset1:33
  v_mfma_f32_16x16x32_bf16 v[68:71], a[28:31], a[216:219], v[68:71]
  v_mul_f32 v90, s52, v90
  v_mul_f32 v91, s52, v91
  v_mfma_f32_16x16x32_bf16 v[168:171], a[224:227], a[220:223], v[168:171]
  v_cvt_pk_bf16_f32 v40, v40, v132
  v_cvt_pk_bf16_f32 v132, v41, v133
  v_mfma_f32_16x16x32_bf16 v[168:171], a[28:31], a[24:27], v[168:171]
  v_cvt_pk_bf16_f32 v42, v42, v134
  v_cvt_pk_bf16_f32 v134, v43, v135
  v_mfma_f32_16x16x32_bf16 v[44:47], a[188:191], a[244:247], v[44:47]
  buffer_store_dwordx2 v[86:87], v252, s[28:31], s86 offen offset:128 sc1 nt
  v_mfma_f32_16x16x32_bf16 v[44:47], a[192:195], v[184:187], v[44:47]
  s_mov_b32 s86, 2097152
  ds_read2_b32 v[118:119], v255 offset0:1 offset1:33
  v_mfma_f32_16x16x32_bf16 v[44:47], a[228:231], a[32:35], v[44:47]
  v_cvt_pk_bf16_f32 v41, v68, v168
  v_cvt_pk_bf16_f32 v133, v69, v169
  v_mfma_f32_16x16x32_bf16 v[44:47], a[232:235], a[36:39], v[44:47]
  v_cvt_pk_bf16_f32 v43, v70, v170
  v_cvt_pk_bf16_f32 v135, v71, v171
  v_mfma_f32_16x16x32_bf16 v[44:47], a[196:199], a[52:55], v[44:47]
  buffer_store_dwordx2 v[40:41], v252, s[28:31], s86 offen offset:128 sc1 nt
  v_mfma_f32_16x16x32_bf16 v[44:47], a[16:19], a[108:111], v[44:47]
  s_mov_b32 s86, 2129920
  v_mfma_f32_16x16x32_bf16 v[44:47], a[20:23], a[160:163], v[44:47]
  v_mfma_f32_16x16x32_bf16 v[44:47], a[236:239], a[124:127], v[44:47]
  v_mfma_f32_16x16x32_bf16 v[44:47], a[64:67], a[204:207], v[44:47]
  buffer_store_dwordx2 v[132:133], v252, s[28:31], s86 offen offset:128 sc1 nt
  v_mfma_f32_16x16x32_bf16 v[44:47], a[40:43], a[100:103], v[44:47]
  s_mov_b32 s86, 2162688
  v_mfma_f32_16x16x32_bf16 v[96:99], a[188:191], v[212:215], v[96:99]
  s_waitcnt lgkmcnt(1)
  v_lshlrev_b32 v164, 16, v180
  v_and_b32 v108, s47, v180
  v_mfma_f32_16x16x32_bf16 v[96:99], a[192:195], v[20:23], v[96:99]
  v_lshlrev_b32 v165, 16, v181
  v_and_b32 v109, s47, v181
  v_mfma_f32_16x16x32_bf16 v[96:99], a[228:231], a[132:135], v[96:99]
  buffer_store_dwordx2 v[42:43], v252, s[28:31], s86 offen offset:128 sc1 nt
  v_mfma_f32_16x16x32_bf16 v[96:99], a[232:235], a[4:7], v[96:99]
  s_mov_b32 s86, 2195456
  v_lshlrev_b32 v166, 16, v182
  v_and_b32 v110, s47, v182
  v_mfma_f32_16x16x32_bf16 v[96:99], a[196:199], a[60:63], v[96:99]
  v_lshlrev_b32 v167, 16, v183
  v_and_b32 v111, s47, v183
  v_mfma_f32_16x16x32_bf16 v[96:99], a[16:19], a[120:123], v[96:99]
  v_lshlrev_b32 v60, 16, v116
  v_and_b32 v156, s47, v116
  v_mfma_f32_16x16x32_bf16 v[96:99], a[20:23], a[168:171], v[96:99]
  buffer_store_dwordx2 v[134:135], v252, s[28:31], s86 offen offset:128 sc1 nt
  v_mfma_f32_16x16x32_bf16 v[96:99], a[236:239], a[76:79], v[96:99]
  v_lshlrev_b32 v61, 16, v117
  v_and_b32 v157, s47, v117
  v_mfma_f32_16x16x32_bf16 v[96:99], a[64:67], a[156:159], v[96:99]
  s_waitcnt lgkmcnt(0)
  v_lshlrev_b32 v62, 16, v118
  v_and_b32 v158, s47, v118
  v_mfma_f32_16x16x32_bf16 v[96:99], a[40:43], a[176:179], v[96:99]
  v_lshlrev_b32 v63, 16, v119
  v_and_b32 v159, s47, v119
  v_mfma_f32_16x16x32_bf16 v[76:79], a[188:191], a[200:203], v[76:79]
  v_mul_f32 v164, s52, v164
  v_mul_f32 v165, s52, v165
  v_mfma_f32_16x16x32_bf16 v[76:79], a[192:195], a[8:11], v[76:79]
  v_mul_f32 v166, s52, v166
  v_mul_f32 v167, s52, v167
  v_mfma_f32_16x16x32_bf16 v[76:79], a[228:231], v[24:27], v[76:79]
  v_cvt_pk_bf16_f32 v44, v44, v96
  v_cvt_pk_bf16_f32 v96, v45, v97
  v_mfma_f32_16x16x32_bf16 v[76:79], a[232:235], a[48:51], v[76:79]
  v_cvt_pk_bf16_f32 v46, v46, v98
  v_cvt_pk_bf16_f32 v98, v47, v99
  v_mfma_f32_16x16x32_bf16 v[76:79], a[196:199], a[148:151], v[76:79]
  v_mul_f32 v108, s52, v108
  v_mul_f32 v109, s52, v109
  v_mfma_f32_16x16x32_bf16 v[76:79], a[16:19], a[152:155], v[76:79]
  v_mul_f32 v110, s52, v110
  v_mul_f32 v111, s52, v111
  v_mfma_f32_16x16x32_bf16 v[76:79], a[20:23], a[80:83], v[76:79]
  v_mul_f32 v60, s52, v60
  v_mul_f32 v61, s52, v61
  v_mfma_f32_16x16x32_bf16 v[76:79], a[236:239], a[240:243], v[76:79]
  v_mul_f32 v62, s52, v62
  v_mul_f32 v63, s52, v63
  v_mfma_f32_16x16x32_bf16 v[76:79], a[64:67], a[180:183], v[76:79]
  v_mul_f32 v156, s52, v156
  v_mul_f32 v157, s52, v157
  v_mfma_f32_16x16x32_bf16 v[76:79], a[40:43], a[216:219], v[76:79]
  v_mul_f32 v158, s52, v158
  v_mul_f32 v159, s52, v159
  v_mfma_f32_16x16x32_bf16 v[88:91], a[188:191], a[208:211], v[88:91]
  v_mfma_f32_16x16x32_bf16 v[88:91], a[192:195], a[212:215], v[88:91]
  v_mfma_f32_16x16x32_bf16 v[88:91], a[228:231], a[12:15], v[88:91]
  v_add_u32 v254, s35, v254
  v_add_u32 v255, s35, v255
  v_mfma_f32_16x16x32_bf16 v[88:91], a[232:235], a[56:59], v[88:91]
  ds_read2_b32 v[92:93], v254 offset0:0 offset1:32
  v_mfma_f32_16x16x32_bf16 v[88:91], a[196:199], a[136:139], v[88:91]
  ds_read2_b32 v[94:95], v255 offset0:0 offset1:32
  v_mfma_f32_16x16x32_bf16 v[88:91], a[16:19], a[112:115], v[88:91]
  v_mfma_f32_16x16x32_bf16 v[88:91], a[20:23], a[0:3], v[88:91]
  ds_read2_b32 v[4:5], v254 offset0:1 offset1:33
  v_mfma_f32_16x16x32_bf16 v[88:91], a[236:239], a[164:167], v[88:91]
  v_mfma_f32_16x16x32_bf16 v[88:91], a[64:67], a[220:223], v[88:91]
  v_mfma_f32_16x16x32_bf16 v[88:91], a[40:43], a[24:27], v[88:91]
  s_mov_b32 s86, 4194304
  ds_read2_b32 v[6:7], v255 offset0:1 offset1:33
  v_mfma_f32_16x16x32_bf16 v[164:167], a[44:47], a[244:247], v[164:167]
  v_mfma_f32_16x16x32_bf16 v[164:167], v[176:179], v[184:187], v[164:167]
  v_mfma_f32_16x16x32_bf16 v[164:167], v[32:35], a[32:35], v[164:167]
  v_mfma_f32_16x16x32_bf16 v[164:167], v[240:243], a[36:39], v[164:167]
  v_mfma_f32_16x16x32_bf16 v[164:167], v[196:199], a[52:55], v[164:167]
  v_mfma_f32_16x16x32_bf16 v[164:167], a[84:87], a[108:111], v[164:167]
  v_cvt_pk_bf16_f32 v45, v76, v88
  v_cvt_pk_bf16_f32 v97, v77, v89
  v_mfma_f32_16x16x32_bf16 v[164:167], v[216:219], a[160:163], v[164:167]
  v_cvt_pk_bf16_f32 v47, v78, v90
  v_cvt_pk_bf16_f32 v99, v79, v91
  v_mfma_f32_16x16x32_bf16 v[164:167], v[200:203], a[124:127], v[164:167]
  buffer_store_dwordx2 v[44:45], v252, s[28:31], s86 offen offset:128 sc1 nt
  v_mfma_f32_16x16x32_bf16 v[164:167], v[80:83], a[204:207], v[164:167]
  s_mov_b32 s86, 4227072
  v_mfma_f32_16x16x32_bf16 v[164:167], v[8:11], a[100:103], v[164:167]
  v_mfma_f32_16x16x32_bf16 v[108:111], a[44:47], v[212:215], v[108:111]
  v_mfma_f32_16x16x32_bf16 v[108:111], v[176:179], v[20:23], v[108:111]
  buffer_store_dwordx2 v[96:97], v252, s[28:31], s86 offen offset:128 sc1 nt
  v_mfma_f32_16x16x32_bf16 v[108:111], v[32:35], a[132:135], v[108:111]
  s_mov_b32 s86, 4259840
  s_waitcnt lgkmcnt(0)
  v_lshlrev_b32 v0, 16, v92
  v_and_b32 v204, s47, v92
  v_mfma_f32_16x16x32_bf16 v[108:111], v[240:243], a[4:7], v[108:111]
  v_lshlrev_b32 v1, 16, v93
  v_and_b32 v205, s47, v93
  v_mfma_f32_16x16x32_bf16 v[108:111], v[196:199], a[60:63], v[108:111]
  v_lshlrev_b32 v2, 16, v94
  v_and_b32 v206, s47, v94
  v_mfma_f32_16x16x32_bf16 v[108:111], a[84:87], a[120:123], v[108:111]
  buffer_store_dwordx2 v[46:47], v252, s[28:31], s86 offen offset:128 sc1 nt
  v_mfma_f32_16x16x32_bf16 v[108:111], v[216:219], a[168:171], v[108:111]
  s_mov_b32 s86, 4292608
  v_lshlrev_b32 v3, 16, v95
  v_and_b32 v207, s47, v95
  v_mfma_f32_16x16x32_bf16 v[108:111], v[200:203], a[76:79], v[108:111]
  v_lshlrev_b32 v172, 16, v4
  v_and_b32 v120, s47, v4
  v_mfma_f32_16x16x32_bf16 v[108:111], v[80:83], a[156:159], v[108:111]
  v_lshlrev_b32 v173, 16, v5
  v_and_b32 v121, s47, v5
  v_mfma_f32_16x16x32_bf16 v[108:111], v[8:11], a[176:179], v[108:111]
  buffer_store_dwordx2 v[98:99], v252, s[28:31], s86 offen offset:128 sc1 nt
  v_mfma_f32_16x16x32_bf16 v[60:63], a[44:47], a[200:203], v[60:63]
  v_lshlrev_b32 v174, 16, v6
  v_and_b32 v122, s47, v6
  v_mfma_f32_16x16x32_bf16 v[60:63], v[176:179], a[8:11], v[60:63]
  v_lshlrev_b32 v175, 16, v7
  v_and_b32 v123, s47, v7
  v_mfma_f32_16x16x32_bf16 v[60:63], v[32:35], v[24:27], v[60:63]
  v_cvt_pk_bf16_f32 v164, v164, v108
  v_cvt_pk_bf16_f32 v108, v165, v109
  v_mfma_f32_16x16x32_bf16 v[60:63], v[240:243], a[48:51], v[60:63]
  v_cvt_pk_bf16_f32 v166, v166, v110
  v_cvt_pk_bf16_f32 v110, v167, v111
  v_mfma_f32_16x16x32_bf16 v[60:63], v[196:199], a[148:151], v[60:63]
  v_mul_f32 v0, s52, v0
  v_mul_f32 v1, s52, v1
  v_mfma_f32_16x16x32_bf16 v[60:63], a[84:87], a[152:155], v[60:63]
  v_mul_f32 v2, s52, v2
  v_mul_f32 v3, s52, v3
  v_mfma_f32_16x16x32_bf16 v[60:63], v[216:219], a[80:83], v[60:63]
  v_mul_f32 v204, s52, v204
  v_mul_f32 v205, s52, v205
  v_mfma_f32_16x16x32_bf16 v[60:63], v[200:203], a[240:243], v[60:63]
  v_mul_f32 v206, s52, v206
  v_mul_f32 v207, s52, v207
  v_mfma_f32_16x16x32_bf16 v[60:63], v[80:83], a[180:183], v[60:63]
  v_mul_f32 v172, s52, v172
  v_mul_f32 v173, s52, v173
  v_mfma_f32_16x16x32_bf16 v[60:63], v[8:11], a[216:219], v[60:63]
  v_mul_f32 v174, s52, v174
  v_mul_f32 v175, s52, v175
  v_mfma_f32_16x16x32_bf16 v[156:159], a[44:47], a[208:211], v[156:159]
  v_mul_f32 v120, s52, v120
  v_mul_f32 v121, s52, v121
  v_mfma_f32_16x16x32_bf16 v[156:159], v[176:179], a[212:215], v[156:159]
  v_mul_f32 v122, s52, v122
  v_mul_f32 v123, s52, v123
  v_mfma_f32_16x16x32_bf16 v[156:159], v[32:35], a[12:15], v[156:159]
  v_mfma_f32_16x16x32_bf16 v[156:159], v[240:243], a[56:59], v[156:159]
  v_mfma_f32_16x16x32_bf16 v[156:159], v[196:199], a[136:139], v[156:159]
  v_mfma_f32_16x16x32_bf16 v[156:159], a[84:87], a[112:115], v[156:159]
  v_mfma_f32_16x16x32_bf16 v[156:159], v[216:219], a[0:3], v[156:159]
  v_mfma_f32_16x16x32_bf16 v[156:159], v[200:203], a[164:167], v[156:159]
  v_mfma_f32_16x16x32_bf16 v[156:159], v[80:83], a[220:223], v[156:159]
  v_mfma_f32_16x16x32_bf16 v[156:159], v[8:11], a[24:27], v[156:159]
  s_mov_b32 s86, 6291456
  v_mfma_f32_16x16x32_bf16 v[0:3], a[88:91], a[244:247], v[0:3]
  v_mfma_f32_16x16x32_bf16 v[0:3], v[52:55], v[184:187], v[0:3]
  v_mfma_f32_16x16x32_bf16 v[0:3], a[92:95], a[32:35], v[0:3]
  v_mfma_f32_16x16x32_bf16 v[0:3], a[96:99], a[36:39], v[0:3]
  v_mfma_f32_16x16x32_bf16 v[0:3], v[140:143], a[52:55], v[0:3]
  v_mfma_f32_16x16x32_bf16 v[0:3], a[104:107], a[108:111], v[0:3]
  v_mfma_f32_16x16x32_bf16 v[0:3], a[116:119], a[160:163], v[0:3]
  v_cvt_pk_bf16_f32 v165, v60, v156
  v_cvt_pk_bf16_f32 v109, v61, v157
  v_mfma_f32_16x16x32_bf16 v[0:3], v[160:163], a[124:127], v[0:3]
  v_cvt_pk_bf16_f32 v167, v62, v158
  v_cvt_pk_bf16_f32 v111, v63, v159
  v_mfma_f32_16x16x32_bf16 v[0:3], v[124:127], a[204:207], v[0:3]
  buffer_store_dwordx2 v[164:165], v252, s[28:31], s86 offen offset:128 sc1 nt
  v_mfma_f32_16x16x32_bf16 v[0:3], v[152:155], a[100:103], v[0:3]
  s_mov_b32 s86, 6324224
  v_mfma_f32_16x16x32_bf16 v[204:207], a[88:91], v[212:215], v[204:207]
  v_mfma_f32_16x16x32_bf16 v[204:207], v[52:55], v[20:23], v[204:207]
  v_mfma_f32_16x16x32_bf16 v[204:207], a[92:95], a[132:135], v[204:207]
  buffer_store_dwordx2 v[108:109], v252, s[28:31], s86 offen offset:128 sc1 nt
  v_mfma_f32_16x16x32_bf16 v[204:207], a[96:99], a[4:7], v[204:207]
  s_mov_b32 s86, 6356992
  v_mfma_f32_16x16x32_bf16 v[204:207], v[140:143], a[60:63], v[204:207]
  v_mfma_f32_16x16x32_bf16 v[204:207], a[104:107], a[120:123], v[204:207]
  v_mfma_f32_16x16x32_bf16 v[204:207], a[116:119], a[168:171], v[204:207]
  buffer_store_dwordx2 v[166:167], v252, s[28:31], s86 offen offset:128 sc1 nt
  v_mfma_f32_16x16x32_bf16 v[204:207], v[160:163], a[76:79], v[204:207]
  s_mov_b32 s86, 6389760
  v_mfma_f32_16x16x32_bf16 v[204:207], v[124:127], a[156:159], v[204:207]
  v_mfma_f32_16x16x32_bf16 v[204:207], v[152:155], a[176:179], v[204:207]
  v_mfma_f32_16x16x32_bf16 v[172:175], a[88:91], a[200:203], v[172:175]
  buffer_store_dwordx2 v[110:111], v252, s[28:31], s86 offen offset:128 sc1 nt
  v_mfma_f32_16x16x32_bf16 v[172:175], v[52:55], a[8:11], v[172:175]
  v_mfma_f32_16x16x32_bf16 v[172:175], a[92:95], v[24:27], v[172:175]
  v_mfma_f32_16x16x32_bf16 v[172:175], a[96:99], a[48:51], v[172:175]
  v_mfma_f32_16x16x32_bf16 v[172:175], v[140:143], a[148:151], v[172:175]
  v_mfma_f32_16x16x32_bf16 v[172:175], a[104:107], a[152:155], v[172:175]
  v_mfma_f32_16x16x32_bf16 v[172:175], a[116:119], a[80:83], v[172:175]
  v_cvt_pk_bf16_f32 v0, v0, v204
  v_cvt_pk_bf16_f32 v204, v1, v205
  v_mfma_f32_16x16x32_bf16 v[172:175], v[160:163], a[240:243], v[172:175]
  v_cvt_pk_bf16_f32 v2, v2, v206
  v_cvt_pk_bf16_f32 v206, v3, v207
  v_mfma_f32_16x16x32_bf16 v[172:175], v[124:127], a[180:183], v[172:175]
  v_mfma_f32_16x16x32_bf16 v[172:175], v[152:155], a[216:219], v[172:175]
  v_mfma_f32_16x16x32_bf16 v[120:123], a[88:91], a[208:211], v[120:123]
  v_mfma_f32_16x16x32_bf16 v[120:123], v[52:55], a[212:215], v[120:123]
  v_mfma_f32_16x16x32_bf16 v[120:123], a[92:95], a[12:15], v[120:123]
  v_mfma_f32_16x16x32_bf16 v[120:123], a[96:99], a[56:59], v[120:123]
  v_mfma_f32_16x16x32_bf16 v[120:123], v[140:143], a[136:139], v[120:123]
  v_mfma_f32_16x16x32_bf16 v[120:123], a[104:107], a[112:115], v[120:123]
  v_mfma_f32_16x16x32_bf16 v[120:123], a[116:119], a[0:3], v[120:123]
  v_mfma_f32_16x16x32_bf16 v[120:123], v[160:163], a[164:167], v[120:123]
  v_mfma_f32_16x16x32_bf16 v[120:123], v[124:127], a[220:223], v[120:123]
  v_mfma_f32_16x16x32_bf16 v[120:123], v[152:155], a[24:27], v[120:123]
  s_mov_b32 s86, 8388608
  s_nop 6
  v_cvt_pk_bf16_f32 v1, v172, v120
  buffer_store_dwordx2 v[0:1], v252, s[28:31], s86 offen offset:128 sc1 nt
  s_mov_b32 s86, 8421376
  v_cvt_pk_bf16_f32 v205, v173, v121
  buffer_store_dwordx2 v[204:205], v252, s[28:31], s86 offen offset:128 sc1 nt
  s_mov_b32 s86, 8454144
  v_cvt_pk_bf16_f32 v3, v174, v122
  buffer_store_dwordx2 v[2:3], v252, s[28:31], s86 offen offset:128 sc1 nt
  s_mov_b32 s86, 8486912
  v_cvt_pk_bf16_f32 v207, v175, v123
  buffer_store_dwordx2 v[206:207], v252, s[28:31], s86 offen offset:128 sc1 nt
L_end:
s_endpgm
.p2align 2
L_pg5:
  s_cbranch_execz L_ret
s_endpgm
.section .rodata,"a"
.p2align 6
.amdhsa_kernel standalone__edm_precond__diffusion_kernel
  .amdhsa_next_free_vgpr 512
  .amdhsa_next_free_sgpr 102
  .amdhsa_accum_offset 256
  .amdhsa_group_segment_fixed_size 0
  .amdhsa_kernarg_size 64
  .amdhsa_user_sgpr_count 2
  .amdhsa_user_sgpr_kernarg_segment_ptr 1
  .amdhsa_system_sgpr_workgroup_id_x 1
.end_amdhsa_kernel
```
